```python
import torch

def _softmax(x, axis=-1):
    return torch.softmax(x, dim=axis)

def _gelu(x):
    return torch.nn.functional.gelu(x, approximate='tanh')

def _silu(x):
    return torch.nn.functional.silu(x)

def _sigmoid(x):
    return torch.sigmoid(x)

def _layernorm(x, axis=-1, eps=1e-05):
    m = x.mean(dim=axis, keepdim=True)
    v = x.var(dim=axis, keepdim=True, unbiased=False)
    return (x - m) / torch.sqrt(v + eps)

def _scatter_add(tgt, idx, src, axis=0):
    return tgt.clone().index_add_(axis, idx, src)

def _segment_sum(src, seg, n):
    out = torch.zeros((n,) + src.shape[1:], dtype=src.dtype)
    return out.index_add_(0, seg, src)

def _pad(x, pw):
    flat = tuple((v for pair in reversed(pw) for v in pair))
    return torch.nn.functional.pad(x, flat)
kernel_name = 'sequential_preLN__spectral_fnet__mixer_gmlp__prompt'

def setup_inputs():

    _w = lambda a: (lambda t: t.to(torch.bfloat16) if t.is_floating_point() else t)(torch.as_tensor(a))

    def _A_setup():
        B, S, D = (1, 2048, 512)
        ns = torch.arange(S)[:, None] * torch.arange(S)[None, :]
        nd = torch.arange(D)[:, None] * torch.arange(D)[None, :]
        Ws_re = torch.cos(-2.0 * torch.pi * ns / S).to(float)
        Ws_im = torch.sin(-2.0 * torch.pi * ns / S).to(float)
        Wd_re = torch.cos(-2.0 * torch.pi * nd / D).to(float)
        Wd_im = torch.sin(-2.0 * torch.pi * nd / D).to(float)
        return {'x': _w((lambda *s: torch.randn(*s, dtype=torch.bfloat16) * 0.05)(B, S, D)), 'dft_seq_re': _w(Ws_re), 'dft_seq_im': _w(Ws_im), 'dft_hid_re': _w(Wd_re), 'dft_hid_im': _w(Wd_im)}
    _A_in = _A_setup()

    def _B_setup():
        B, S, D, F = (1, 2048, 512, 1376)
        Fh = F // 2
        return {'x': _w((lambda *s: torch.randn(*s, dtype=torch.bfloat16) * 0.05)(B, S, D)), 'w_in': _w((lambda *s: torch.randn(*s, dtype=torch.bfloat16) * 1.6)(D, 2 * Fh)), 'w_sp': _w(0.01 * (lambda *s: torch.randn(*s, dtype=torch.bfloat16) * 1.6)(S, S)), 'b_sp': _w(1.0 + 0.01 * (lambda *s: torch.randn(*s, dtype=torch.bfloat16) * 0.8)(S)), 'w_out': _w((lambda *s: torch.randn(*s, dtype=torch.bfloat16) * 0.8)(Fh, D))}
    _B_in = _B_setup()
    return {'A_x': _A_in['x'], 'A_dft_seq_re': _A_in['dft_seq_re'], 'A_dft_seq_im': _A_in['dft_seq_im'], 'A_dft_hid_re': _A_in['dft_hid_re'], 'A_dft_hid_im': _A_in['dft_hid_im'], 'B_x': _B_in['x'], 'B_w_in': _B_in['w_in'], 'B_w_sp': _B_in['w_sp'], 'B_b_sp': _B_in['b_sp'], 'B_w_out': _B_in['w_out']}

def reference(A_x, A_dft_seq_re, A_dft_seq_im, A_dft_hid_re, A_dft_hid_im, B_x, B_w_in, B_w_sp, B_b_sp, B_w_out):

    def _A_ref(x, dft_seq_re, dft_seq_im, dft_hid_re, dft_hid_im):
        a = torch.einsum('bsd,ed->bse', x, dft_hid_re)
        b = torch.einsum('bsd,ed->bse', x, dft_hid_im)
        y = torch.einsum('ts,bse->bte', dft_seq_re, a) - torch.einsum('ts,bse->bte', dft_seq_im, b)
        return y

    def _B_ref(x, w_in, w_sp, b_sp, w_out):
        B, S, D = x.shape
        F = w_in.shape[-1]
        Fh = F // 2
        z = _gelu(torch.einsum('bsd,df->bsf', x, w_in))
        z1 = z[..., :Fh].clone()
        z2 = _layernorm(z[..., Fh:], axis=-1)
        g = torch.einsum('ts,bsf->btf', w_sp, z2) + b_sp[None, :, None]
        return torch.einsum('bsf,fd->bsd', z1 * g, w_out)
    x = A_x
    h = x + _A_ref(_layernorm(x, axis=-1), A_dft_seq_re, A_dft_seq_im, A_dft_hid_re, A_dft_hid_im)
    h2 = h + _B_ref(_layernorm(h, axis=-1), B_w_in, B_w_sp, B_b_sp, B_w_out)
    return h2
```

```asm
; @launch grid=(256,1,1) block=(256,1,1) lds=163840
.amdgcn_target "amdgcn-amd-amdhsa--gfx950"
.text
.globl sequential_preLN__spectral_fnet__mixer_gmlp__prompt_kernel
.p2align 8
.type sequential_preLN__spectral_fnet__mixer_gmlp__prompt_kernel,@function
sequential_preLN__spectral_fnet__mixer_gmlp__prompt_kernel:
    s_load_dwordx2 s[8:9], s[0:1], 0
    s_load_dwordx2 s[12:13], s[0:1], 48
    s_load_dwordx2 s[16:17], s[0:1], 56
    s_load_dwordx2 s[28:29], s[0:1], 96
    s_load_dwordx2 s[20:21], s[0:1], 72
    s_load_dwordx2 s[32:33], s[0:1], 64
    s_load_dwordx2 s[24:25], s[0:1], 80
    s_cmp_ge_u32 s2, 256
    s_cbranch_scc1 L_end
    s_getpc_b64 s[4:5]
L_pc:
    s_lshr_b32 s67, s2, 3
    v_lshrrev_b32 v6, 6, v0
    v_and_b32 v7, 3, v0
    v_lshl_add_u32 v7, v6, 2, v7
    v_lshl_add_u32 v7, v7, 5, s67
    v_lshlrev_b32 v7, 7, v7
    v_min_u32 v7, L_codeend-L_pc-4, v7
    global_load_dword a255, v7, s[4:5]
    v_readfirstlane_b32 s54, v6
    v_and_b32 v1, 63, v0
    v_and_b32 v2, 31, v0
    v_bfe_u32 v3, v0, 5, 1
    v_lshlrev_b32 v4, 4, v1
    s_and_b32 s70, s2, 15
    s_sub_u32 s72, 32, s70
    s_cmp_eq_u32 s70, 0
    s_cselect_b32 s72, 16, s72
    s_bitcmp1_b32 s2, 4
    s_cselect_b32 s57, s72, s70
    s_lshr_b32 s58, s2, 5
    s_and_b32 s68, s58, 3
    v_lshrrev_b32 v6, 4, v1
    v_and_b32 v7, 15, v1
    v_xor_b32 v7, v7, v6
    v_lshlrev_b32 v7, 4, v7
    v_lshl_add_u32 v20, v6, 15, v7
    v_xor_b32 v21, 64, v20
    v_add_u32 v21, 130048, v21
    v_xor_b32 v22, 128, v20
    v_add_u32 v22, 260096, v22
    v_xor_b32 v23, 192, v20
    v_add_u32 v23, 390144, v23
    s_lshl_b32 s71, s57, 10
    s_lshl_b32 s72, s54, 19
    s_add_u32 s90, s71, s72
    s_lshl_b32 s91, s54, 14
    s_mov_b32 s10, 2097152
    s_mov_b32 s11, 0x20000
    v_and_b32 v6, 12, v1
    v_and_b32 v7, 3, v1
    v_lshl_add_u32 v6, v6, 1, v7
    s_and_b32 s70, s54, 1
    s_lshl_b32 s70, s70, 2
    s_lshl_b32 s71, s58, 5
    s_add_u32 s70, s70, s71
    v_add_u32 v6, s70, v6
    v_mov_b32 v7, 0x100
    v_cmp_eq_u32 vcc, 0, v6
    s_nop 1
    v_cndmask_b32 v6, v6, v7, vcc
    v_cvt_f32_u32 v6, v6
    v_mul_f32 v74, 0x3b000000, v6
    v_mul_f32 v75, 0x41c80000, v74
    v_lshrrev_b32 v7, 4, v1
    s_lshl_b32 s70, s68, 4
    v_add_u32 v7, s70, v7
    v_cvt_f32_u32 v7, v7
    v_mul_f32 v7, 0x41000000, v7
    v_mul_f32 v7, v7, v74
    v_fract_f32 v7, v7
    s_cmp_lt_u32 s54, 2
    s_cselect_b32 s70, 0x3e800000, 0.5
    v_add_f32 v76, s70, v7
    s_waitcnt lgkmcnt(0)
    s_add_u32 s89, s68, 0
    s_and_b32 s89, s89, 3
    s_lshl_b32 s89, s89, 8
    s_add_u32 s89, s89, s90
    s_add_u32 m0, s91, 0
    s_nop 0
    buffer_load_dwordx4 v20, s[8:11], s89 offen offset:0 lds
    s_lshr_b32 s55, s54, 1
    s_and_b32 s56, s54, 1
    s_sub_u32 s72, 64, s57
    s_cmp_eq_u32 s57, 0
    s_cselect_b32 s72, 32, s72
    s_cselect_b32 s73, 0, s56
    s_xor_b32 s63, s55, s73
    s_cmp_eq_u32 s55, 0
    s_cselect_b32 s61, s57, s72
    s_cselect_b32 s62, s72, s57
    s_lshl_b32 s72, s72, 10
    buffer_load_dwordx4 v21, s[8:11], s89 offen offset:1024 lds
    s_lshl_b32 s73, s55, 20
    s_add_u32 s60, s72, s73
    s_lshl_b32 s94, s61, 12
    s_lshl_b32 s95, s62, 12
    s_lshr_b32 s70, s58, 1
    s_xor_b32 s3, s54, s70
    s_lshl_b32 s70, s3, 2
    s_and_b32 s71, s3, 2
    s_add_u32 s70, s70, s71
    s_lshl_b32 s70, s70, 8
    s_lshl_b32 s71, s56, 22
    s_add_u32 s70, s70, s71
    s_and_b32 s71, s58, 1
    s_lshl_b32 s71, s71, 8
    s_add_u32 s70, s70, s71
    buffer_load_dwordx4 v22, s[8:11], s89 offen offset:2048 lds
    s_add_u32 s94, s94, s70
    s_add_u32 s95, s95, s70
    s_mov_b32 s18, 8388608
    s_mov_b32 s19, s11
    v_lshrrev_b32 v8, 3, v1
    v_lshlrev_b32 v8, 15, v8
    v_and_b32 v7, 7, v1
    v_lshl_add_u32 v10, v7, 4, v8
    s_lshl_b32 s70, s54, 19
    s_lshl_b32 s71, s58, 12
    s_add_u32 s70, s70, s71
    s_lshl_b32 s71, s57, 7
    s_add_u32 s70, s70, s71
    s_add_u32 s76, s70, 1048576
    s_add_u32 s77, s76, 262144
    buffer_load_dwordx4 v23, s[8:11], s89 offen offset:3072 lds
    s_lshl_b32 s70, s57, 1
    s_add_u32 s70, s70, s55
    s_lshl_b32 s81, s70, 12
    s_add_u32 s81, s81, 3145728
    s_lshl_b32 s70, s58, 1
    s_add_u32 s70, s70, s56
    s_lshl_b32 s70, s70, 8
    s_add_u32 s82, s70, s81
    v_lshlrev_b32 v12, 2, v1
    v_accvgpr_write_b32 a248, -1
    v_accvgpr_write_b32 a249, -1
    v_accvgpr_write_b32 a250, -1
    v_accvgpr_write_b32 a251, -1
    s_mov_b32 s30, 67108864
    s_mov_b32 s31, s11
    s_add_u32 s89, s68, 1
    s_and_b32 s89, s89, 3
    s_lshl_b32 s89, s89, 8
    s_add_u32 s89, s89, s90
    s_add_u32 m0, s91, 4096
    s_nop 0
    buffer_load_dwordx4 v20, s[8:11], s89 offen offset:0 lds
    v_sin_f32 v78, v76
    v_add_f32 v76, v76, v74
    v_sin_f32 v79, v76
    v_add_f32 v76, v76, v74
    v_sin_f32 v80, v76
    v_add_f32 v76, v76, v74
    v_sin_f32 v81, v76
    buffer_load_dwordx4 v21, s[8:11], s89 offen offset:1024 lds
    v_cvt_pk_bf16_f32 v32, v78, v79
    v_add_f32 v76, v76, v74
    v_sin_f32 v78, v76
    v_add_f32 v76, v76, v74
    v_sin_f32 v79, v76
    v_cvt_pk_bf16_f32 v33, v80, v81
    v_add_f32 v76, v76, v74
    v_sin_f32 v80, v76
    v_add_f32 v76, v76, v74
    v_sin_f32 v81, v76
    v_cvt_pk_bf16_f32 v34, v78, v79
    buffer_load_dwordx4 v22, s[8:11], s89 offen offset:2048 lds
    v_add_f32 v76, v76, v75
    v_sin_f32 v78, v76
    v_add_f32 v76, v76, v74
    v_sin_f32 v79, v76
    v_cvt_pk_bf16_f32 v35, v80, v81
    v_add_f32 v76, v76, v74
    v_sin_f32 v80, v76
    v_add_f32 v76, v76, v74
    v_sin_f32 v81, v76
    v_cvt_pk_bf16_f32 v36, v78, v79
    v_add_f32 v76, v76, v74
    buffer_load_dwordx4 v23, s[8:11], s89 offen offset:3072 lds
    v_sin_f32 v78, v76
    v_add_f32 v76, v76, v74
    v_sin_f32 v79, v76
    v_cvt_pk_bf16_f32 v37, v80, v81
    v_add_f32 v76, v76, v74
    v_sin_f32 v80, v76
    v_add_f32 v76, v76, v74
    v_sin_f32 v81, v76
    v_cvt_pk_bf16_f32 v38, v78, v79
    v_add_f32 v76, v76, v75
    v_sin_f32 v78, v76
    buffer_store_dwordx4 a[248:251], v10, s[28:31], s76 offen sc1
    v_add_f32 v76, v76, v74
    v_sin_f32 v79, v76
    v_cvt_pk_bf16_f32 v39, v80, v81
    v_add_f32 v76, v76, v74
    v_sin_f32 v80, v76
    v_add_f32 v76, v76, v74
    v_sin_f32 v81, v76
    v_cvt_pk_bf16_f32 v40, v78, v79
    v_add_f32 v76, v76, v74
    v_sin_f32 v78, v76
    v_add_f32 v76, v76, v74
    buffer_store_dwordx4 a[248:251], v10, s[28:31], s77 offen sc1
    v_sin_f32 v79, v76
    v_cvt_pk_bf16_f32 v41, v80, v81
    v_add_f32 v76, v76, v74
    v_sin_f32 v80, v76
    v_add_f32 v76, v76, v74
    v_sin_f32 v81, v76
    v_cvt_pk_bf16_f32 v42, v78, v79
    v_add_f32 v76, v76, v75
    v_sin_f32 v78, v76
    v_add_f32 v76, v76, v74
    v_sin_f32 v79, v76
    buffer_store_dword a248, v12, s[28:31], s82 offen sc1
    v_cvt_pk_bf16_f32 v43, v80, v81
    v_add_f32 v76, v76, v74
    v_sin_f32 v80, v76
    v_add_f32 v76, v76, v74
    v_sin_f32 v81, v76
    v_cvt_pk_bf16_f32 v44, v78, v79
    v_add_f32 v76, v76, v74
    v_sin_f32 v78, v76
    v_add_f32 v76, v76, v74
    v_sin_f32 v79, v76
    v_cvt_pk_bf16_f32 v45, v80, v81
    v_add_f32 v76, v76, v74
    v_sin_f32 v80, v76
    v_add_f32 v76, v76, v74
    v_sin_f32 v81, v76
    v_cvt_pk_bf16_f32 v46, v78, v79
    v_cvt_pk_bf16_f32 v47, v80, v81
    s_lshl_b32 s70, s54, 12
    s_add_u32 s70, s70, 98304
    v_add_u32 v6, s70, v4
    ds_write_b128 v6, v[32:35] offset:0
    ds_write_b128 v6, v[36:39] offset:1024
    ds_write_b128 v6, v[40:43] offset:2048
    ds_write_b128 v6, v[44:47] offset:3072
    s_bfe_u32 s70, s2, 0x20004
    s_mul_i32 s71, s70, 176
    s_cmp_eq_u32 s70, 3
    s_cselect_b32 s73, 10, 11
    s_lshr_b32 s70, s2, 6
    s_xor_b32 s70, s70, 2
    s_mul_i32 s70, s70, 688
    s_add_u32 s71, s71, s70
    v_and_b32 v6, 15, v1
    v_lshl_add_u32 v7, v6, 4, s71
    v_mov_b32 v8, 0x40000000
    v_cmp_gt_u32 vcc, s73, v6
    s_nop 1
    v_cndmask_b32 v7, v8, v7, vcc
    s_and_b32 s70, s2, 7
    s_lshl_b32 s70, s70, 2
    s_add_u32 s70, s70, s54
    s_lshl_b32 s70, s70, 3
    s_bfe_i32 s71, s2, 0x10003
    s_and_b32 s73, s71, 256
    s_movk_i32 s74, 2752
    v_lshrrev_b32 v6, 4, v1
    v_add_u32 v6, s70, v6
    v_xor_b32 v8, s71, v6
    v_subrev_u32 v8, s71, v8
    v_and_b32 v8, 255, v8
    v_add_u32 v8, s73, v8
    v_mad_u32_u24 v68, v8, s74, v7
    v_add_u32 v6, 4, v6
    v_xor_b32 v8, s71, v6
    v_subrev_u32 v8, s71, v8
    s_add_u32 s89, s68, 3
    s_and_b32 s89, s89, 3
    s_lshl_b32 s89, s89, 8
    s_add_u32 s89, s89, s90
    s_add_u32 m0, s91, 12288
    s_nop 0
    buffer_load_dwordx4 v20, s[8:11], s89 offen offset:0 lds
    v_and_b32 v8, 255, v8
    v_add_u32 v8, s73, v8
    v_mad_u32_u24 v69, v8, s74, v7
    s_lshl_b32 s66, s54, 12
    s_add_u32 s66, s66, 147456
    s_mov_b32 s14, 1409024
    s_mov_b32 s15, s11
    s_waitcnt lgkmcnt(0)
    s_barrier
    v_add_u32 v94, 98304, v4
    buffer_load_dwordx4 v21, s[8:11], s89 offen offset:1024 lds
    ds_read_b128 a[0:3], v94 offset:0
    s_bfe_u32 s70, s2, 0x10003
    v_bfe_u32 v6, v1, 4, 1
    v_xor_b32 v6, s70, v6
    ds_read_b128 a[16:19], v94 offset:4096
    v_lshlrev_b32 v6, 5, v6
    v_lshl_add_u32 v6, v3, 6, v6
    v_bfe_u32 v7, v1, 2, 2
    ds_read_b128 a[32:35], v94 offset:8192
    v_lshl_add_u32 v6, v7, 8, v6
    v_and_b32 v7, 3, v1
    v_lshl_add_u32 v6, v7, 3, v6
    ds_read_b128 a[48:51], v94 offset:12288
    v_add_u32 v72, s66, v6
    v_lshlrev_b32 v6, 4, v2
    buffer_load_dwordx4 v22, s[8:11], s89 offen offset:2048 lds
    v_lshl_add_u32 v73, v3, 10, v6
    ds_read_b128 a[4:7], v94 offset:1024
    v_lshl_add_u32 v66, v3, 30, v6
    s_xor_b32 s70, s2, 128
    s_lshl_b32 s70, s70, 1
    ds_read_b128 a[20:23], v94 offset:5120
    s_add_u32 s70, s70, s55
    s_mul_i32 s70, s70, 3072
    s_lshl_b32 s71, s56, 9
    ds_read_b128 a[36:39], v94 offset:9216
    s_add_u32 s70, s70, s71
    s_add_u32 s59, s70, 10485760
    v_and_b32 v6, 15, v1
    ds_read_b128 a[52:55], v94 offset:13312
    v_lshrrev_b32 v7, 4, v1
    buffer_load_dwordx4 v23, s[8:11], s89 offen offset:3072 lds
    v_xor_b32 v8, v6, v7
    v_lshlrev_b32 v8, 4, v8
    ds_read_b128 a[8:11], v94 offset:2048
    v_lshl_add_u32 v8, v6, 8, v8
    s_lshl_b32 s70, s54, 14
    v_add_u32 v14, s70, v8
    ds_read_b128 a[24:27], v94 offset:6144
    v_xor_b32 v15, 64, v14
    v_xor_b32 v16, 128, v14
    v_xor_b32 v17, 192, v14
    ds_read_b128 a[40:43], v94 offset:10240
    v_mov_b32 v60, 0x3f803f80
    v_mov_b32 v61, v60
    v_mov_b32 v62, v60
    ds_read_b128 a[56:59], v94 offset:14336
    s_add_u32 m0, s66, 0
    s_nop 0
    buffer_load_dwordx4 v68, s[12:15], 0 offen lds
    v_mov_b32 v63, v60
    v_lshrrev_b32 v8, 2, v6
    v_lshl_add_u32 v8, v8, 4, v6
    ds_read_b128 a[12:15], v94 offset:3072
    v_lshlrev_b32 v86, 2, v8
    v_lshlrev_b32 v6, 6, v6
    v_lshl_add_u32 v6, v7, 4, v6
    ds_read_b128 a[28:31], v94 offset:7168
    s_lshl_b32 s70, s54, 10
    s_add_u32 s70, s70, 131072
    v_add_u32 v82, s70, v6
    ds_read_b128 a[44:47], v94 offset:11264
    v_lshrrev_b32 v6, 4, v1
    v_lshlrev_b32 v6, 15, v6
    s_add_u32 m0, s66, 1024
    s_nop 0
    buffer_load_dwordx4 v69, s[12:15], 0 offen lds
    v_add_u32 v56, v20, v6
    ds_read_b128 a[60:63], v94 offset:15360
    v_add_u32 v6, 131072, v6
    v_add_u32 v57, v21, v6
    v_add_u32 v6, 131072, v6
    v_add_u32 v58, v22, v6
    s_add_u32 s89, s68, 2
    s_and_b32 s89, s89, 3
    s_lshl_b32 s89, s89, 8
    s_add_u32 s89, s89, s90
    s_add_u32 m0, s91, 8192
    s_nop 0
    buffer_load_dwordx4 v20, s[8:11], s89 offen offset:0 lds
    s_waitcnt vmcnt(14)
    ds_read_b128 v[160:163], v14 offset:0
    ds_read_b128 v[164:167], v15 offset:0
    ds_read_b128 v[168:171], v16 offset:0
    ds_read_b128 v[172:175], v17 offset:0
    s_waitcnt lgkmcnt(0)
    v_mfma_f32_16x16x32_bf16 v[48:51], v[60:63], v[160:163], 0
    v_add_u32 v6, 131072, v6
    v_add_u32 v59, v23, v6
    v_mfma_f32_16x16x32_bf16 v[128:131], a[0:3], v[160:163], 0
    buffer_load_dwordx4 v21, s[8:11], s89 offen offset:1024 lds
    s_add_u32 s86, s91, 98304
    v_lshrrev_b32 v6, 4, v1
    v_mfma_f32_16x16x32_bf16 v[132:135], a[16:19], v[160:163], 0
    v_and_b32 v7, 0xf0, v20
    v_lshl_add_u32 v44, v6, 18, v7
    v_mfma_f32_16x16x32_bf16 v[52:55], v[160:163], v[160:163], 0
    v_xor_b32 v45, 64, v44
    v_add_u32 v45, 1047552, v45
    v_mfma_f32_16x16x32_bf16 v[136:139], a[32:35], v[160:163], 0
    v_xor_b32 v46, 128, v44
    v_add_u32 v46, 2095104, v46
    v_mfma_f32_16x16x32_bf16 v[140:143], a[48:51], v[160:163], 0
    buffer_load_dwordx4 v22, s[8:11], s89 offen offset:2048 lds
    v_xor_b32 v47, 192, v44
    v_add_u32 v47, 3142656, v47
    v_mfma_f32_16x16x32_bf16 v[48:51], v[60:63], v[164:167], v[48:51]
    s_lshr_b32 s70, s2, 3
    s_mul_i32 s70, s70, 0
    v_mfma_f32_16x16x32_bf16 v[128:131], a[4:7], v[164:167], v[128:131]
    s_lshl_b32 s65, s2, 4
    s_add_u32 s65, s65, s70
    v_mfma_f32_16x16x32_bf16 v[132:135], a[20:23], v[164:167], v[132:135]
    s_lshl_b32 s70, s54, 2
    s_add_u32 s65, s65, s70
    v_mfma_f32_16x16x32_bf16 v[52:55], v[164:167], v[164:167], v[52:55]
    buffer_load_dwordx4 v23, s[8:11], s89 offen offset:3072 lds
    s_add_u32 s65, s65, 12582912
    s_mov_b32 s22, 704512
    v_mfma_f32_16x16x32_bf16 v[136:139], a[36:39], v[164:167], v[136:139]
    s_mov_b32 s23, s11
    s_movk_i32 s34, 4096
    v_mfma_f32_16x16x32_bf16 v[140:143], a[52:55], v[164:167], v[140:143]
    s_mov_b32 s35, s11
    s_mov_b32 s26, s10
    v_mfma_f32_16x16x32_bf16 v[48:51], v[60:63], v[168:171], v[48:51]
    s_mov_b32 s27, s11
    v_bfe_u32 v8, v1, 2, 2
    v_mfma_f32_16x16x32_bf16 v[128:131], a[8:11], v[168:171], v[128:131]
    buffer_load_dword v89, off, s[28:31], 0 offset:0 sc1
    v_lshlrev_b32 v8, 6, v8
    v_lshl_add_u32 v8, v3, 9, v8
    v_mfma_f32_16x16x32_bf16 v[132:135], a[24:27], v[168:171], v[132:135]
    s_waitcnt vmcnt(14)
    ds_read_b128 v[176:179], v14 offset:4096
    ds_read_b128 v[180:183], v15 offset:4096
    ds_read_b128 v[184:187], v16 offset:4096
    ds_read_b128 v[188:191], v17 offset:4096
    v_mfma_f32_16x16x32_bf16 v[52:55], v[168:171], v[168:171], v[52:55]
    v_bfe_u32 v6, v1, 4, 1
    v_lshl_add_u32 v8, v6, 5, v8
    v_mfma_f32_16x16x32_bf16 v[136:139], a[40:43], v[168:171], v[136:139]
    v_and_b32 v6, 1, v1
    s_lshl_b32 s89, s56, 1
    s_add_u32 s89, s89, s68
    s_add_u32 s89, s89, 0
    s_and_b32 s89, s89, 3
    s_lshl_b32 s89, s89, 8
    s_add_u32 s89, s89, s60
    s_lshl_b32 s6, s54, 13
    s_add_u32 m0, s6, 65536
    s_nop 0
    buffer_load_dwordx4 v56, s[8:11], s89 offen offset:0 lds
    v_lshl_add_u32 v8, v6, 4, v8
    v_mfma_f32_16x16x32_bf16 v[140:143], a[56:59], v[168:171], v[140:143]
    v_bfe_u32 v6, v1, 1, 1
    v_lshl_add_u32 v5, v6, 3, v8
    v_mfma_f32_16x16x32_bf16 v[48:51], v[60:63], v[172:175], v[48:51]
    buffer_load_dwordx4 v57, s[8:11], s89 offen offset:1024 lds
    v_add_u32 v83, 131072, v5
    s_mul_i32 s70, s54, 2304
    v_mfma_f32_16x16x32_bf16 v[128:131], a[12:15], v[172:175], v[128:131]
    s_add_u32 s70, s70, 98304
    v_lshrrev_b32 v6, 1, v2
    v_mfma_f32_16x16x32_bf16 v[132:135], a[28:31], v[172:175], v[132:135]
    v_mul_u32_u24 v6, 144, v6
    v_and_b32 v7, 1, v2
    v_mfma_f32_16x16x32_bf16 v[52:55], v[172:175], v[172:175], v[52:55]
    v_lshl_add_u32 v6, v7, 6, v6
    v_lshl_add_u32 v6, v3, 4, v6
    v_mfma_f32_16x16x32_bf16 v[136:139], a[44:47], v[172:175], v[136:139]
    buffer_load_dwordx4 v58, s[8:11], s89 offen offset:2048 lds
    v_add_u32 v84, s70, v6
    v_lshrrev_b32 v6, 3, v1
    v_mfma_f32_16x16x32_bf16 v[140:143], a[60:63], v[172:175], v[140:143]
    v_mul_u32_u24 v6, 144, v6
    v_and_b32 v7, 7, v1
    s_waitcnt lgkmcnt(0)
    v_mfma_f32_16x16x32_bf16 v[48:51], v[60:63], v[176:179], v[48:51]
    v_lshl_add_u32 v6, v7, 4, v6
    v_add_u32 v85, s70, v6
    v_mfma_f32_16x16x32_bf16 v[224:227], a[0:3], v[176:179], 0
    v_lshrrev_b32 v6, 1, v2
    s_lshl_b32 s70, s54, 4
    v_mfma_f32_16x16x32_bf16 v[228:231], a[16:19], v[176:179], 0
    buffer_load_dwordx4 v59, s[8:11], s89 offen offset:3072 lds
    v_add_u32 v6, s70, v6
    v_cvt_f32_u32 v6, v6
    v_mfma_f32_16x16x32_bf16 v[52:55], v[176:179], v[176:179], v[52:55]
    v_mul_f32 v74, 0x3c800000, v6
    v_mul_f32 v75, 0x41100000, v74
    v_mfma_f32_16x16x32_bf16 v[232:235], a[32:35], v[176:179], 0
    v_cvt_f32_u32 v7, v3
    v_mul_f32 v7, 0x41000000, v7
    v_mfma_f32_16x16x32_bf16 v[236:239], a[48:51], v[176:179], 0
    v_and_b32 v9, 1, v2
    v_cvt_f32_u32 v8, v9
    v_mfma_f32_16x16x32_bf16 v[48:51], v[60:63], v[180:183], v[48:51]
    s_lshl_b32 s89, s56, 1
    s_add_u32 s89, s89, s68
    s_add_u32 s89, s89, 1
    s_and_b32 s89, s89, 3
    s_lshl_b32 s89, s89, 8
    s_add_u32 s89, s89, s60
    s_lshl_b32 s6, s54, 13
    s_add_u32 m0, s6, 69632
    s_nop 0
    buffer_load_dwordx4 v56, s[8:11], s89 offen offset:0 lds
    v_mov_b32 v76, 0x3e800000
    v_fmac_f32 v76, 0x3e800000, v8
    v_mfma_f32_16x16x32_bf16 v[224:227], a[4:7], v[180:183], v[224:227]
    v_cvt_f32_u32 v8, s57
    v_mul_f32 v8, 0x3a000000, v8
    v_mfma_f32_16x16x32_bf16 v[228:231], a[20:23], v[180:183], v[228:231]
    buffer_load_dwordx4 v57, s[8:11], s89 offen offset:1024 lds
    v_fmac_f32 v76, v6, v8
    v_fmac_f32 v76, v7, v74
    v_mfma_f32_16x16x32_bf16 v[52:55], v[180:183], v[180:183], v[52:55]
    v_xor_b32 v9, 1, v9
    v_mul_u32_u24 v9, 0x8000, v9
    v_mfma_f32_16x16x32_bf16 v[232:235], a[36:39], v[180:183], v[232:235]
    v_lshl_or_b32 v77, v9, 16, v9
    v_sin_f32 v78, v76
    v_mfma_f32_16x16x32_bf16 v[236:239], a[52:55], v[180:183], v[236:239]
    v_add_f32 v76, v76, v74
    v_sin_f32 v79, v76
    buffer_load_dwordx4 v58, s[8:11], s89 offen offset:2048 lds
    v_mfma_f32_16x16x32_bf16 v[48:51], v[60:63], v[184:187], v[48:51]
    v_add_f32 v76, v76, v74
    v_sin_f32 v80, v76
    v_mfma_f32_16x16x32_bf16 v[224:227], a[8:11], v[184:187], v[224:227]
    v_add_f32 v76, v76, v74
    v_sin_f32 v81, v76
    v_mfma_f32_16x16x32_bf16 v[228:231], a[24:27], v[184:187], v[228:231]
    s_waitcnt vmcnt(14)
    ds_read_b128 v[160:163], v14 offset:12288
    ds_read_b128 v[164:167], v15 offset:12288
    ds_read_b128 v[168:171], v16 offset:12288
    buffer_load_dwordx4 v59, s[8:11], s89 offen offset:3072 lds
    ds_read_b128 v[172:175], v17 offset:12288
    v_mfma_f32_16x16x32_bf16 v[52:55], v[184:187], v[184:187], v[52:55]
    v_cvt_pk_bf16_f32 v96, v78, v79
    v_add_f32 v76, v76, v74
    v_mfma_f32_16x16x32_bf16 v[232:235], a[40:43], v[184:187], v[232:235]
    v_sin_f32 v78, v76
    v_mfma_f32_16x16x32_bf16 v[236:239], a[56:59], v[184:187], v[236:239]
    v_add_f32 v76, v76, v74
    v_sin_f32 v79, v76
    v_mfma_f32_16x16x32_bf16 v[48:51], v[60:63], v[188:191], v[48:51]
    s_waitcnt vmcnt(13)
    ds_read_b64_tr_b16 v[192:193], v72
    ds_read_b64_tr_b16 v[194:195], v72 offset:1024
    ds_read_b64_tr_b16 v[196:197], v72 offset:128
    ds_read_b64_tr_b16 v[198:199], v72 offset:1152
    v_cvt_pk_bf16_f32 v97, v80, v81
    v_add_f32 v76, v76, v74
    v_mfma_f32_16x16x32_bf16 v[224:227], a[12:15], v[188:191], v[224:227]
    v_sin_f32 v80, v76
    v_mfma_f32_16x16x32_bf16 v[228:231], a[28:31], v[188:191], v[228:231]
    v_add_f32 v76, v76, v74
    v_sin_f32 v81, v76
    v_mfma_f32_16x16x32_bf16 v[52:55], v[188:191], v[188:191], v[52:55]
    s_waitcnt lgkmcnt(2)
    buffer_store_dwordx4 v[192:195], v73, s[28:31], s59 offen sc1
    v_cvt_pk_bf16_f32 v98, v78, v79
    v_add_f32 v76, v76, v75
    v_mfma_f32_16x16x32_bf16 v[232:235], a[44:47], v[188:191], v[232:235]
    v_sin_f32 v78, v76
    v_mfma_f32_16x16x32_bf16 v[236:239], a[60:63], v[188:191], v[236:239]
    v_add_f32 v76, v76, v74
    v_sin_f32 v79, v76
    v_mfma_f32_16x16x32_bf16 v[48:51], v[60:63], v[160:163], v[48:51]
    v_cvt_pk_bf16_f32 v99, v80, v81
    v_add_f32 v76, v76, v74
    s_waitcnt lgkmcnt(0)
    buffer_store_dwordx4 v[196:199], v66, s[28:31], s59 offen offset:2048 sc1
    v_mfma_f32_16x16x32_bf16 v[240:243], a[0:3], v[160:163], 0
    v_sin_f32 v80, v76
    v_mfma_f32_16x16x32_bf16 v[244:247], a[16:19], v[160:163], 0
    v_add_f32 v128, v128, v224
    v_add_f32 v129, v129, v233
    v_mfma_f32_16x16x32_bf16 v[52:55], v[160:163], v[160:163], v[52:55]
    v_sub_f32 v130, v130, v226
    v_sub_f32 v131, v131, v235
    v_mfma_f32_16x16x32_bf16 v[248:251], a[32:35], v[160:163], 0
    v_add_f32 v132, v132, v228
    s_waitcnt vmcnt(10)
    v_readfirstlane_b32 s64, v89
    s_nop 0
    s_mul_i32 s64, s64, 0x9e3779b1
    s_add_u32 s64, s64, 0x7f4a7c15
    v_mov_b32 v31, s64
    s_barrier
    s_cmp_eq_u32 s54, 0
    s_cselect_b32 s65, s65, 0x40000000
    s_mov_b64 exec, 15
    buffer_store_dword v31, v12, s[28:31], s65 offen sc1
    s_mov_b64 exec, -1
    v_add_f32 v133, v133, v237
    v_mfma_f32_16x16x32_bf16 v[252:255], a[48:51], v[160:163], 0
    v_sub_f32 v134, v134, v230
    v_sub_f32 v135, v135, v239
    v_mfma_f32_16x16x32_bf16 v[48:51], v[60:63], v[164:167], v[48:51]
    s_xor_b32 s91, s94, 0
    s_sub_u32 m0, s66, 0
    s_nop 0
    buffer_load_dwordx4 v44, s[16:19], s91 offen offset:0 lds
    v_add_f32 v136, v136, v232
    v_sub_f32 v137, v137, v225
    v_mfma_f32_16x16x32_bf16 v[240:243], a[4:7], v[164:167], v[240:243]
    v_sub_f32 v138, v138, v234
    v_add_f32 v139, v139, v227
    v_mfma_f32_16x16x32_bf16 v[244:247], a[20:23], v[164:167], v[244:247]
    v_add_f32 v140, v140, v236
    v_sub_f32 v141, v141, v229
    v_mfma_f32_16x16x32_bf16 v[52:55], v[164:167], v[164:167], v[52:55]
    v_sub_f32 v142, v142, v238
    buffer_load_dwordx4 v45, s[16:19], s91 offen offset:1024 lds
    v_add_f32 v143, v143, v231
    v_mfma_f32_16x16x32_bf16 v[248:251], a[36:39], v[164:167], v[248:251]
    v_add_f32 v76, v76, v74
    v_sin_f32 v81, v76
    v_mfma_f32_16x16x32_bf16 v[252:255], a[52:55], v[164:167], v[252:255]
    v_cvt_pk_bf16_f32 v100, v78, v79
    v_add_f32 v76, v76, v74
    v_mfma_f32_16x16x32_bf16 v[48:51], v[60:63], v[168:171], v[48:51]
    v_sin_f32 v78, v76
    v_mfma_f32_16x16x32_bf16 v[240:243], a[8:11], v[168:171], v[240:243]
    buffer_load_dwordx4 v46, s[16:19], s91 offen offset:2048 lds
    v_add_f32 v76, v76, v74
    v_sin_f32 v79, v76
    v_mfma_f32_16x16x32_bf16 v[244:247], a[24:27], v[168:171], v[244:247]
    ds_read_b128 v[176:179], v14 offset:8192
    ds_read_b128 v[180:183], v15 offset:8192
    ds_read_b128 v[184:187], v16 offset:8192
    ds_read_b128 v[188:191], v17 offset:8192
    v_mfma_f32_16x16x32_bf16 v[52:55], v[168:171], v[168:171], v[52:55]
    v_cvt_pk_bf16_f32 v101, v80, v81
    v_add_f32 v76, v76, v74
    v_mfma_f32_16x16x32_bf16 v[248:251], a[40:43], v[168:171], v[248:251]
    buffer_load_dwordx4 v47, s[16:19], s91 offen offset:3072 lds
    v_sin_f32 v80, v76
    v_mfma_f32_16x16x32_bf16 v[252:255], a[56:59], v[168:171], v[252:255]
    v_add_f32 v76, v76, v74
    v_sin_f32 v81, v76
    v_mfma_f32_16x16x32_bf16 v[48:51], v[60:63], v[172:175], v[48:51]
    v_cvt_pk_bf16_f32 v102, v78, v79
    v_add_f32 v76, v76, v75
    v_mfma_f32_16x16x32_bf16 v[240:243], a[12:15], v[172:175], v[240:243]
    v_sin_f32 v78, v76
    s_lshl_b32 s6, s56, 10
    s_add_u32 s6, s6, s61
    s_lshl_b32 s6, s6, 1
    v_and_b32 v67, 15, v1
    v_lshlrev_b32 v67, 7, v67
    buffer_load_ushort v18, v67, s[32:35], s6 offen
    v_mfma_f32_16x16x32_bf16 v[244:247], a[28:31], v[172:175], v[244:247]
    v_add_f32 v76, v76, v74
    v_sin_f32 v79, v76
    v_mfma_f32_16x16x32_bf16 v[52:55], v[172:175], v[172:175], v[52:55]
    v_cvt_pk_bf16_f32 v103, v80, v81
    v_add_f32 v76, v76, v74
    v_mfma_f32_16x16x32_bf16 v[248:251], a[44:47], v[172:175], v[248:251]
    v_sin_f32 v80, v76
    v_mfma_f32_16x16x32_bf16 v[252:255], a[60:63], v[172:175], v[252:255]
    v_add_f32 v76, v76, v74
    v_sin_f32 v81, v76
    s_waitcnt lgkmcnt(0)
    v_mfma_f32_16x16x32_bf16 v[52:55], v[176:179], v[176:179], v[52:55]
    v_cvt_pk_bf16_f32 v104, v78, v79
    v_add_f32 v76, v76, v74
    v_mfma_f32_16x16x32_bf16 v[48:51], v[60:63], v[176:179], v[48:51]
    v_sin_f32 v78, v76
    v_mfma_f32_16x16x32_bf16 v[52:55], v[180:183], v[180:183], v[52:55]
    v_add_f32 v128, v128, v240
    v_sub_f32 v129, v129, v249
    v_mfma_f32_16x16x32_bf16 v[48:51], v[60:63], v[180:183], v[48:51]
    v_sub_f32 v130, v130, v242
    v_add_f32 v131, v131, v251
    v_mfma_f32_16x16x32_bf16 v[52:55], v[184:187], v[184:187], v[52:55]
    v_add_f32 v132, v132, v244
    v_sub_f32 v133, v133, v253
    v_mfma_f32_16x16x32_bf16 v[48:51], v[60:63], v[184:187], v[48:51]
    v_sub_f32 v134, v134, v246
    v_add_f32 v135, v135, v255
    v_mfma_f32_16x16x32_bf16 v[52:55], v[188:191], v[188:191], v[52:55]
    v_add_f32 v136, v136, v248
    v_add_f32 v137, v137, v241
    v_mfma_f32_16x16x32_bf16 v[48:51], v[60:63], v[188:191], v[48:51]
    v_sub_f32 v138, v138, v250
    v_sub_f32 v139, v139, v243
    v_mfma_f32_16x16x32_bf16 v[144:147], a[0:3], v[176:179], 0
    v_add_f32 v140, v140, v252
    v_add_f32 v141, v141, v245
    v_mfma_f32_16x16x32_bf16 v[148:151], a[16:19], v[176:179], 0
    s_mov_b32 vcc_lo, 0xaaaaaaaa
    s_mov_b32 vcc_hi, vcc_lo
    v_mfma_f32_16x16x32_bf16 v[144:147], a[4:7], v[180:183], v[144:147]
    v_cndmask_b32 v52, v52, v53, vcc
    v_cndmask_b32 v54, v54, v55, vcc
    v_mfma_f32_16x16x32_bf16 v[148:151], a[20:23], v[180:183], v[148:151]
    s_mov_b32 vcc_lo, 0xcccccccc
    s_mov_b32 vcc_hi, vcc_lo
    v_mfma_f32_16x16x32_bf16 v[144:147], a[8:11], v[184:187], v[144:147]
    v_cndmask_b32 v52, v52, v54, vcc
    ds_bpermute_b32 v87, v86, v52
    v_mfma_f32_16x16x32_bf16 v[148:151], a[24:27], v[184:187], v[148:151]
    v_mul_f32 v90, 0x3b000000, v48
    v_mul_f32 v90, v90, v90
    v_mfma_f32_16x16x32_bf16 v[144:147], a[12:15], v[188:191], v[144:147]
    v_sub_f32 v90, 0x3727c5ac, v90
    v_sub_f32 v142, v142, v254
    v_mfma_f32_16x16x32_bf16 v[148:151], a[28:31], v[188:191], v[148:151]
    v_sub_f32 v143, v143, v247
    v_nop
    v_mfma_f32_16x16x32_bf16 v[152:155], a[32:35], v[176:179], 0
    v_nop
    v_nop
    v_mfma_f32_16x16x32_bf16 v[156:159], a[48:51], v[176:179], 0
    v_nop
    s_waitcnt lgkmcnt(0)
    v_fmac_f32 v90, 0x3b000000, v87
    v_mfma_f32_16x16x32_bf16 v[152:155], a[36:39], v[180:183], v[152:155]
    v_max_f32 v90, 0x3727c5ac, v90
    v_rsq_f32 v92, v90
    v_mfma_f32_16x16x32_bf16 v[156:159], a[52:55], v[180:183], v[156:159]
    v_add_f32 v128, v128, v144
    v_sub_f32 v129, v129, v145
    v_mfma_f32_16x16x32_bf16 v[152:155], a[40:43], v[184:187], v[152:155]
    v_add_f32 v130, v130, v146
    v_sub_f32 v131, v131, v147
    v_mfma_f32_16x16x32_bf16 v[156:159], a[56:59], v[184:187], v[156:159]
    v_add_f32 v132, v132, v148
    v_sub_f32 v133, v133, v149
    v_mfma_f32_16x16x32_bf16 v[152:155], a[44:47], v[188:191], v[152:155]
    v_add_f32 v134, v134, v150
    v_sub_f32 v135, v135, v151
    v_mfma_f32_16x16x32_bf16 v[156:159], a[60:63], v[188:191], v[156:159]
    v_mul_f32 v128, v128, v92
    v_mul_f32 v129, v129, v92
    v_mul_f32 v130, v130, v92
    v_mul_f32 v131, v131, v92
    v_mul_f32 v132, v132, v92
    v_mul_f32 v133, v133, v92
    v_mul_f32 v134, v134, v92
    v_mul_f32 v135, v135, v92
    v_cvt_pk_bf16_f32 v144, v128, v129
    v_cvt_pk_bf16_f32 v145, v130, v131
    v_cvt_pk_bf16_f32 v146, v132, v133
    v_cvt_pk_bf16_f32 v147, v134, v135
    ds_write_b128 v82, v[144:147]
    v_pk_add_f32 v[136:137], v[136:137], v[152:153] neg_hi:[0,1]
    v_pk_add_f32 v[138:139], v[138:139], v[154:155] neg_hi:[0,1]
    v_pk_add_f32 v[140:141], v[140:141], v[156:157] neg_hi:[0,1]
    v_pk_add_f32 v[142:143], v[142:143], v[158:159] neg_hi:[0,1]
    v_pk_mul_f32 v[136:137], v[136:137], v[92:93] op_sel_hi:[1,0]
    v_pk_mul_f32 v[138:139], v[138:139], v[92:93] op_sel_hi:[1,0]
    v_pk_mul_f32 v[140:141], v[140:141], v[92:93] op_sel_hi:[1,0]
    v_pk_mul_f32 v[142:143], v[142:143], v[92:93] op_sel_hi:[1,0]
    v_cvt_pk_bf16_f32 v148, v136, v137
    v_cvt_pk_bf16_f32 v149, v138, v139
    v_cvt_pk_bf16_f32 v150, v140, v141
    v_cvt_pk_bf16_f32 v151, v142, v143
    ds_write_b128 v82, v[148:151] offset:4096
    v_add_f32 v76, v76, v74
    v_sin_f32 v79, v76
    v_cvt_pk_bf16_f32 v105, v80, v81
    v_add_f32 v76, v76, v74
    v_sin_f32 v80, v76
    v_add_f32 v76, v76, v74
    v_sin_f32 v81, v76
    v_cvt_pk_bf16_f32 v106, v78, v79
    v_add_f32 v76, v76, v75
    v_sin_f32 v78, v76
    v_add_f32 v76, v76, v74
    v_sin_f32 v79, v76
    v_cvt_pk_bf16_f32 v107, v80, v81
    v_add_f32 v76, v76, v74
    v_sin_f32 v80, v76
    v_add_f32 v76, v76, v74
    v_sin_f32 v81, v76
    v_cvt_pk_bf16_f32 v108, v78, v79
    v_add_f32 v76, v76, v74
    v_sin_f32 v78, v76
    v_add_f32 v76, v76, v74
    v_sin_f32 v79, v76
    v_cvt_pk_bf16_f32 v109, v80, v81
    v_add_f32 v76, v76, v74
    v_sin_f32 v80, v76
    v_add_f32 v76, v76, v74
    v_sin_f32 v81, v76
    v_cvt_pk_bf16_f32 v110, v78, v79
    v_cvt_pk_bf16_f32 v111, v80, v81
    v_xor_b32_dpp v112, v96, v77 quad_perm:[1,0,3,2] row_mask:0xf bank_mask:0xf
    v_xor_b32_dpp v113, v97, v77 quad_perm:[1,0,3,2] row_mask:0xf bank_mask:0xf
    v_xor_b32_dpp v114, v98, v77 quad_perm:[1,0,3,2] row_mask:0xf bank_mask:0xf
    v_xor_b32_dpp v115, v99, v77 quad_perm:[1,0,3,2] row_mask:0xf bank_mask:0xf
    v_xor_b32_dpp v116, v100, v77 quad_perm:[1,0,3,2] row_mask:0xf bank_mask:0xf
    v_xor_b32_dpp v117, v101, v77 quad_perm:[1,0,3,2] row_mask:0xf bank_mask:0xf
    v_xor_b32_dpp v118, v102, v77 quad_perm:[1,0,3,2] row_mask:0xf bank_mask:0xf
    v_xor_b32_dpp v119, v103, v77 quad_perm:[1,0,3,2] row_mask:0xf bank_mask:0xf
    v_xor_b32_dpp v120, v104, v77 quad_perm:[1,0,3,2] row_mask:0xf bank_mask:0xf
    v_xor_b32_dpp v121, v105, v77 quad_perm:[1,0,3,2] row_mask:0xf bank_mask:0xf
    v_xor_b32_dpp v122, v106, v77 quad_perm:[1,0,3,2] row_mask:0xf bank_mask:0xf
    v_xor_b32_dpp v123, v107, v77 quad_perm:[1,0,3,2] row_mask:0xf bank_mask:0xf
    v_xor_b32_dpp v124, v108, v77 quad_perm:[1,0,3,2] row_mask:0xf bank_mask:0xf
    v_xor_b32_dpp v125, v109, v77 quad_perm:[1,0,3,2] row_mask:0xf bank_mask:0xf
    v_xor_b32_dpp v126, v110, v77 quad_perm:[1,0,3,2] row_mask:0xf bank_mask:0xf
    v_xor_b32_dpp v127, v111, v77 quad_perm:[1,0,3,2] row_mask:0xf bank_mask:0xf
    s_waitcnt vmcnt(6)
    s_waitcnt lgkmcnt(0)
    s_barrier
    ds_read_b64_tr_b16 v[160:161], v83 offset:0
    ds_read_b64_tr_b16 v[162:163], v83 offset:256
    ds_read_b64_tr_b16 v[164:165], v83 offset:1024
    ds_read_b64_tr_b16 v[166:167], v83 offset:1280
    ds_read_b64_tr_b16 v[168:169], v83 offset:2048
    ds_read_b64_tr_b16 v[170:171], v83 offset:2304
    ds_read_b64_tr_b16 v[172:173], v83 offset:3072
    ds_read_b64_tr_b16 v[174:175], v83 offset:3328
    ds_read_b64_tr_b16 v[176:177], v83 offset:4096
    ds_read_b64_tr_b16 v[178:179], v83 offset:4352
    ds_read_b64_tr_b16 v[180:181], v83 offset:5120
    ds_read_b64_tr_b16 v[182:183], v83 offset:5376
    ds_read_b64_tr_b16 v[184:185], v83 offset:6144
    ds_read_b64_tr_b16 v[186:187], v83 offset:6400
    ds_read_b64_tr_b16 v[188:189], v83 offset:7168
    ds_read_b64_tr_b16 v[190:191], v83 offset:7424
    s_waitcnt lgkmcnt(14)
    v_mfma_f32_32x32x16_bf16 v[128:143], v[160:163], v[96:99], 0
    s_mov_b32 s69, 200000
    s_mov_b32 s39, 0xffff0000
    s_lshl_b32 s70, s61, 15
    s_lshl_b32 s71, s56, 12
    s_add_u32 s70, s70, s71
    s_waitcnt lgkmcnt(12)
    v_mfma_f32_32x32x16_bf16 v[128:143], v[164:167], v[100:103], v[128:143]
    s_add_u32 s88, s70, 1048576
    s_sub_u32 s70, 1, s55
    v_lshlrev_b32 v6, s70, v2
    v_lshrrev_b32 v7, 4, v6
    v_and_b32 v6, 15, v6
    s_waitcnt lgkmcnt(10)
    v_mfma_f32_32x32x16_bf16 v[128:143], v[168:171], v[104:107], v[128:143]
    v_lshlrev_b32 v7, 14, v7
    v_lshl_add_u32 v7, v6, 8, v7
    s_mul_i32 s70, s56, 15
    v_xor_b32 v6, v6, v3
    v_xor_b32 v6, s70, v6
    s_waitcnt lgkmcnt(8)
    v_mfma_f32_32x32x16_bf16 v[128:143], v[172:175], v[108:111], v[128:143]
    v_lshl_add_u32 v7, v6, 4, v7
    s_mul_i32 s72, s55, 65536
    s_and_b32 s70, s70, 3
    s_xor_b32 s71, s70, 0
    s_sub_u32 s71, s71, s68
    s_waitcnt lgkmcnt(6)
    v_mfma_f32_32x32x16_bf16 v[128:143], v[176:179], v[112:115], v[128:143]
    s_and_b32 s71, s71, 3
    s_lshl_b32 s71, s71, 12
    s_add_u32 s71, s71, s72
    v_add_u32 v64, s71, v7
    s_xor_b32 s71, s70, 1
    s_waitcnt lgkmcnt(4)
    v_mfma_f32_32x32x16_bf16 v[128:143], v[180:183], v[116:119], v[128:143]
    s_sub_u32 s71, s71, s68
    s_and_b32 s71, s71, 3
    s_lshl_b32 s71, s71, 12
    s_add_u32 s71, s71, s72
    v_add_u32 v65, s71, v7
    s_waitcnt lgkmcnt(2)
    v_mfma_f32_32x32x16_bf16 v[128:143], v[184:187], v[120:123], v[128:143]
    v_lshrrev_b32 v6, 4, v1
    v_and_b32 v7, 0xf0, v20
    v_lshl_add_u32 v20, v6, 18, v7
    v_xor_b32 v21, 64, v20
    v_add_u32 v21, 1047552, v21
    s_waitcnt lgkmcnt(0)
    v_mfma_f32_32x32x16_bf16 v[128:143], v[188:191], v[124:127], v[128:143]
    v_xor_b32 v22, 128, v20
    v_add_u32 v22, 2095104, v22
    v_xor_b32 v23, 192, v20
    v_add_u32 v23, 3142656, v23
    v_and_b32 v6, 1, v6
    s_nop 6
    v_cvt_pk_bf16_f32 v144, v128, v129
    v_cvt_pk_bf16_f32 v145, v130, v131
    v_cvt_pk_bf16_f32 v146, v132, v133
    v_cvt_pk_bf16_f32 v147, v134, v135
    v_and_b32 v144, -2, v144
    ds_write_b128 v84, v[144:147]
    v_cvt_pk_bf16_f32 v148, v136, v137
    v_cvt_pk_bf16_f32 v149, v138, v139
    v_cvt_pk_bf16_f32 v150, v140, v141
    v_cvt_pk_bf16_f32 v151, v142, v143
    v_and_b32 v148, -2, v148
    ds_write_b128 v84, v[148:151] offset:32
    ds_read_b128 v[200:203], v85
    ds_read_b128 v[204:207], v85 offset:1152
    s_waitcnt lgkmcnt(1)
    buffer_store_dwordx4 v[200:203], v10, s[28:31], s76 offen sc1
    s_waitcnt lgkmcnt(0)
    buffer_store_dwordx4 v[204:207], v10, s[28:31], s77 offen sc1
    v_lshl_add_u32 v6, v3, 3, v6
    v_and_b32 v7, 15, v1
    v_xor_b32 v6, v6, v7
    v_lshlrev_b32 v6, 4, v6
    v_lshl_add_u32 v6, v7, 8, v6
    v_add_u32 v17, s86, v6
    s_sub_u32 s70, s66, 49152
    v_add_u32 v163, s70, v6
    v_lshrrev_b32 v9, 3, v0
    v_mul_u32_u24 v9, 0, v9
    v_lshl_add_u32 v9, v0, 4, v9
    v_add_u32 v9, 12582912, v9
    buffer_load_dwordx4 v[168:171], v9, s[28:31], 0 offen offset:0 sc1
    v_mov_b32 v160, v64
    v_mov_b32 v161, v65
    v_and_b32 v6, 0x13, v2
    v_and_b32 v7, 4, v2
    v_lshl_or_b32 v6, v7, 1, v6
    v_bfe_u32 v7, v2, 3, 1
    v_lshl_or_b32 v6, v7, 2, v6
    v_add_u32 v7, s56, v3
    v_lshlrev_b32 v7, 3, v7
    v_sub_u32 v6, v6, v7
    s_sub_u32 s70, 0, s56
    v_xor_b32 v6, s70, v6
    v_subrev_u32 v6, s70, v6
    v_and_b32 v7, 1, v6
    v_lshlrev_b32 v7, 4, v7
    v_mov_b32 v8, 0x3f80
    v_lshlrev_b32 v7, v7, v8
    v_ashrrev_i32 v6, 1, v6
    s_or_b32 s70, s70, 1
    s_lshl_b32 s70, s70, 3
    v_add_u32 v6, s70, v6
    v_cmp_eq_u32 s[46:47], 0, v6
    v_cmp_eq_u32 s[48:49], 1, v6
    v_cmp_eq_u32 s[50:51], 2, v6
    v_cmp_eq_u32 s[52:53], 3, v6
    v_cndmask_b32 v208, 0, v7, s[46:47]
    v_cndmask_b32 v209, 0, v7, s[48:49]
    v_cndmask_b32 v210, 0, v7, s[50:51]
    v_cndmask_b32 v211, 0, v7, s[52:53]
    v_subrev_u32 v6, s70, v6
    v_cmp_eq_u32 s[46:47], 0, v6
    v_cmp_eq_u32 s[48:49], 1, v6
    v_cmp_eq_u32 s[50:51], 2, v6
    v_cmp_eq_u32 s[52:53], 3, v6
    v_cndmask_b32 v212, 0, v7, s[46:47]
    v_cndmask_b32 v213, 0, v7, s[48:49]
    v_cndmask_b32 v214, 0, v7, s[50:51]
    v_cndmask_b32 v215, 0, v7, s[52:53]
    v_subrev_u32 v6, s70, v6
    v_cmp_eq_u32 s[46:47], 0, v6
    v_cmp_eq_u32 s[48:49], 1, v6
    v_cmp_eq_u32 s[50:51], 2, v6
    v_cmp_eq_u32 s[52:53], 3, v6
    v_cndmask_b32 v216, 0, v7, s[46:47]
    v_cndmask_b32 v217, 0, v7, s[48:49]
    v_cndmask_b32 v218, 0, v7, s[50:51]
    v_cndmask_b32 v219, 0, v7, s[52:53]
    s_barrier
    s_xor_b32 s91, s94, 256
    s_sub_u32 m0, s66, 16384
    s_nop 0
    buffer_load_dwordx4 v20, s[16:19], s91 offen offset:0 lds
    v_xor_b32 v162, 224, v161
    ds_read_b128 v[220:223], v162
    ds_read_b128 v[184:187], v160
    v_xor_b32 v162, 32, v160
    ds_read_b128 v[188:191], v162
    v_xor_b32 v162, 64, v160
    ds_read_b128 v[192:195], v162
    v_xor_b32 v162, 96, v160
    ds_read_b128 v[196:199], v162
    v_xor_b32 v162, 128, v160
    ds_read_b128 v[200:203], v162
    s_waitcnt lgkmcnt(5)
    v_mfma_f32_32x32x16_bf16 v[32:47], v[208:211], v[220:223], 0
    buffer_load_dwordx4 v21, s[16:19], s91 offen offset:1024 lds
    v_xor_b32 v162, 160, v160
    ds_read_b128 v[204:207], v162
    s_waitcnt vmcnt(5)
    v_lshlrev_b32 v18, 16, v18
    s_mov_b32 s4, 0xbdd2d3e8
    s_mov_b32 s5, s4
    v_mov_b32 v174, 0xc0135761
    s_waitcnt lgkmcnt(5)
    v_mfma_f32_32x32x16_bf16 v[32:47], v[212:215], v[184:187], v[32:47]
    v_xor_b32 v162, 192, v160
    ds_read_b128 v[184:187], v162
    v_mov_b32 v175, 1.0
    v_bfe_u32 v6, v1, 3, 2
    v_lshl_add_u32 v6, v6, 2, v4
    v_add_u32 v13, s86, v6
    s_waitcnt lgkmcnt(5)
    v_mfma_f32_32x32x16_bf16 v[32:47], v[216:219], v[188:191], v[32:47]
    buffer_load_dwordx4 v22, s[16:19], s91 offen offset:2048 lds
    v_and_b32 v6, 0x33, v1
    v_and_b32 v7, 4, v1
    v_lshl_or_b32 v6, v7, 1, v6
    v_bfe_u32 v7, v1, 3, 1
    v_mfma_f32_32x32x16_bf16 v[48:63], v[208:211], v[188:191], 0
    v_xor_b32 v162, 224, v160
    ds_read_b128 v[188:191], v162
    v_lshl_or_b32 v6, v7, 2, v6
    s_mul_i32 s70, s56, 3072
    v_lshl_add_u32 v28, v6, 4, s70
    v_add_u32 v25, 49152, v28
    s_waitcnt lgkmcnt(5)
    v_mfma_f32_32x32x16_bf16 v[48:63], v[212:215], v[192:195], v[48:63]
    buffer_load_dwordx4 v23, s[16:19], s91 offen offset:3072 lds
    ds_read_b128 v[192:195], v161
    s_mul_i32 s38, s54, 3072
    s_lshl_b32 s70, s58, 1
    s_add_u32 s70, s70, s56
    s_lshl_b32 s70, s70, 4
    s_waitcnt lgkmcnt(5)
    v_mfma_f32_32x32x16_bf16 v[48:63], v[216:219], v[196:199], v[48:63]
    s_add_u32 s70, s70, s55
    s_mul_i32 s70, s70, 3072
    s_add_u32 s96, s70, 10485760
    s_and_b32 s70, s58, 3
    v_mfma_f32_32x32x16_bf16 v[64:79], v[208:211], v[196:199], 0
    v_xor_b32 v162, 32, v161
    ds_read_b128 v[196:199], v162
    v_mov_b32 v29, v32
    s_cmp_eq_u32 s70, 3
    s_cselect_b32 s70, 16, 24
    s_lshl_b32 s71, s56, 4
    v_xor_b32 v6, s71, v2
    s_waitcnt lgkmcnt(5)
    v_mfma_f32_32x32x16_bf16 v[64:79], v[212:215], v[200:203], v[64:79]
    v_xor_b32 v162, 64, v161
    ds_read_b128 v[200:203], v162
    v_mov_b32 v7, 0x40000000
    v_cmp_gt_u32 vcc, s70, v6
    s_nop 1
    v_cndmask_b32 v24, v7, v4, vcc
    s_lshl_b32 s70, s63, 15
    s_waitcnt lgkmcnt(5)
    v_mfma_f32_32x32x16_bf16 v[64:79], v[216:219], v[204:207], v[64:79]
    s_add_u32 s70, s70, 98304
    v_add_u32 v14, s70, v5
    s_lshl_b32 s70, s54, 8
    s_add_u32 s70, s70, 159744
    v_mfma_f32_32x32x16_bf16 v[80:95], v[208:211], v[204:207], 0
    v_xor_b32 v162, 96, v161
    ds_read_b128 v[204:207], v162
    v_add_u32 v15, s70, v12
    s_lshl_b32 s70, s55, 9
    s_add_u32 s70, s70, 159744
    v_lshl_add_u32 v16, v2, 2, s70
    s_waitcnt lgkmcnt(5)
    v_mfma_f32_32x32x16_bf16 v[80:95], v[212:215], v[184:187], v[80:95]
    v_xor_b32 v162, 128, v161
    ds_read_b128 v[184:187], v162
    ds_read_b128 a[0:3], v163 offset:49152
    v_xor_b32 v224, 32, v163
    ds_read_b128 a[8:11], v224 offset:49152
    v_xor_b32 v224, 64, v163
    ds_read_b128 a[16:19], v224 offset:49152
    v_xor_b32 v224, 96, v163
    ds_read_b128 a[24:27], v224 offset:49152
    s_waitcnt vmcnt(0)
    ds_read_b128 a[4:7], v163 offset:32768
    v_xor_b32 v224, 32, v163
    ds_read_b128 a[12:15], v224 offset:32768
    v_xor_b32 v224, 64, v163
    ds_read_b128 a[20:23], v224 offset:32768
    v_xor_b32 v224, 96, v163
    ds_read_b128 a[28:31], v224 offset:32768
L_ag_1:
    v_xor_b32 v168, s64, v168
    v_xor_b32 v169, s64, v169
    v_xor_b32 v170, s64, v170
    v_xor_b32 v171, s64, v171
    v_or3_b32 v168, v168, v169, v170
    v_or_b32 v168, v168, v171
    v_cmp_ne_u32 vcc, 0, v168
    s_cbranch_vccnz L_rt_2
L_rc_3:
    s_waitcnt lgkmcnt(0)
    s_barrier
    s_add_u32 m0, s86, 12288
    s_add_u32 s89, s88, 0
    buffer_load_dwordx4 v4, s[28:31], s89 offen offset:0 sc1 lds
    v_mov_b32 v164, 0
    v_mov_b32 v165, 0
    v_mov_b32 v166, 0
    v_mov_b32 v167, 0
    v_mfma_f32_32x32x16_bf16 v[80:95], v[216:219], v[188:191], v[80:95]
    s_cmp_eq_u32 s56, 0
    s_cselect_b32 s92, -1, 0
    s_mov_b32 s93, 0
    s_cmp_eq_u32 s61, 0
    s_cselect_b32 s70, 32, 31
    v_sub_u32 v6, s70, v2
    v_mfma_f32_32x32x16_bf16 v[96:111], v[208:211], v[188:191], 0
    buffer_load_dwordx4 v4, s[28:31], s89 offen offset:1024 sc1 lds
    v_xor_b32 v162, 160, v161
    ds_read_b128 v[188:191], v162
    v_and_b32 v6, 31, v6
    s_cmp_eq_u32 s56, 0
    s_cselect_b64 vcc, -1, 0
    v_cndmask_b32 v6, v6, v2, vcc
    v_mfma_f32_32x32x16_bf16 v[96:111], v[212:215], v[192:195], v[96:111]
    v_xor_b32 v162, 192, v161
    ds_read_b128 v[192:195], v162
    v_and_b32 v7, 1, v6
    v_mul_u32_u24 v7, 0x8000, v7
    v_lshl_or_b32 v176, v7, 16, v7
    v_cvt_f32_u32 v6, v6
    v_mfma_f32_32x32x16_bf16 v[96:111], v[216:219], v[196:199], v[96:111]
    buffer_load_dwordx4 v4, s[28:31], s89 offen offset:2048 sc1 lds
    v_mul_f32 v8, 0x3d000000, v6
    v_mul_f32 v177, 0x40a00000, v8
    v_cvt_f32_u32 v7, v3
    v_mul_f32 v7, 4.0, v7
    v_mfma_f32_32x32x16_bf16 v[112:127], v[208:211], v[196:199], 0
    v_mul_f32 v7, v7, v8
    v_cos_f32 v178, v7
    v_sin_f32 v179, v7
    v_mfma_f32_32x32x16_bf16 v[112:127], v[212:215], v[200:203], v[112:127]
    buffer_load_dwordx4 v4, s[28:31], s89 offen offset:3072 sc1 lds
    v_add_f32 v7, v7, v8
    v_cos_f32 v180, v7
    v_sin_f32 v181, v7
    v_mfma_f32_32x32x16_bf16 v[112:127], v[216:219], v[204:207], v[112:127]
    v_cvt_pk_bf16_f32 v240, v178, v179
    v_add_f32 v7, v7, v8
    v_cos_f32 v178, v7
    v_mfma_f32_32x32x16_bf16 v[128:143], v[208:211], v[204:207], 0
    s_add_u32 m0, s86, 8192
    s_add_u32 s89, s88, 8192
    buffer_load_dwordx4 v4, s[28:31], s89 offen offset:0 sc1 lds
    v_sin_f32 v179, v7
    v_cvt_pk_bf16_f32 v241, v180, v181
    v_add_f32 v7, v7, v8
    v_mfma_f32_32x32x16_bf16 v[128:143], v[212:215], v[184:187], v[128:143]
    v_cos_f32 v180, v7
    v_sin_f32 v181, v7
    s_waitcnt lgkmcnt(1)
    v_mfma_f32_32x32x16_bf16 v[128:143], v[216:219], v[188:191], v[128:143]
    buffer_load_dwordx4 v4, s[28:31], s89 offen offset:1024 sc1 lds
    v_cvt_pk_bf16_f32 v242, v178, v179
    v_add_f32 v7, v7, v177
    v_cos_f32 v178, v7
    v_mfma_f32_32x32x16_bf16 v[144:159], v[208:211], v[188:191], 0
    v_sin_f32 v179, v7
    v_cvt_pk_bf16_f32 v243, v180, v181
    v_add_f32 v7, v7, v8
    s_waitcnt lgkmcnt(0)
    v_mfma_f32_32x32x16_bf16 v[144:159], v[212:215], v[192:195], v[144:159]
    buffer_load_dwordx4 v4, s[28:31], s89 offen offset:2048 sc1 lds
    v_cos_f32 v180, v7
    v_sin_f32 v181, v7
    v_mfma_f32_32x32x16_bf16 v[144:159], v[216:219], v[220:223], v[144:159]
    v_cvt_pk_bf16_f32 v244, v178, v179
    v_add_f32 v7, v7, v8
    v_cos_f32 v178, v7
    v_sin_f32 v179, v7
    v_cvt_pk_bf16_f32 v245, v180, v181
    v_add_f32 v7, v7, v8
    buffer_load_dwordx4 v4, s[28:31], s89 offen offset:3072 sc1 lds
    v_cos_f32 v180, v7
    v_sin_f32 v181, v7
    v_cvt_pk_bf16_f32 v246, v178, v179
    v_cvt_pk_bf16_f32 v247, v180, v181
    v_xor_b32 v248, v176, v240
    v_xor_b32 v249, v176, v241
    v_xor_b32 v250, v176, v242
    v_xor_b32 v251, v176, v243
    v_xor_b32 v252, v176, v244
    v_xor_b32 v253, v176, v245
    v_xor_b32 v254, v176, v246
    v_xor_b32 v255, v176, v247
    s_lshl_b32 s70, s57, 1
    s_add_u32 m0, s86, 4096
    s_add_u32 s89, s88, 16384
    buffer_load_dwordx4 v4, s[28:31], s89 offen offset:0 sc1 lds
    s_add_u32 s70, s70, s55
    s_mul_i32 s72, s70, 49152
    s_add_u32 s72, s72, 7340032
    s_mul_i32 s71, s56, 24576
    s_add_u32 s85, s72, s71
    s_mul_i32 s71, s58, 6144
    s_add_u32 s72, s72, s71
    s_lshl_b32 s71, s56, 8
    s_add_u32 s83, s72, s71
    s_add_u32 s84, s83, 4096
    s_lshl_b32 s70, s61, 15
    s_add_u32 s70, s70, 1048576
    s_add_u32 s71, s71, s70
    buffer_load_dwordx4 v4, s[28:31], s89 offen offset:1024 sc1 lds
    s_lshl_b32 s72, s58, 12
    s_add_u32 s83, s71, s72
    s_lshl_b32 s72, s56, 14
    s_add_u32 s45, s70, s72
    s_and_b32 s70, s61, 3
    v_and_b32 v6, 3, v2
    v_xor_b32 v6, s70, v6
    v_lshlrev_b32 v6, 4, v6
    v_lshl_add_u32 v6, v3, 6, v6
    v_lshrrev_b32 v7, 2, v2
    v_lshl_add_u32 v11, v7, 14, v6
    v_and_b32 v7, s56, v3
    v_lshl_add_u32 v10, v7, 30, v11
    s_mul_i32 s70, s58, 393216
    s_add_u32 s70, s70, 4194304
    buffer_load_dwordx4 v4, s[28:31], s89 offen offset:2048 sc1 lds
    s_lshl_b32 s71, s3, 15
    s_add_u32 s87, s70, s71
    s_and_b32 s71, s3, 2
    s_lshl_b32 s71, s71, 13
    s_add_u32 s87, s87, s71
    s_xor_b32 s97, s87, 16384
    s_lshl_b32 s71, s56, 7
    s_add_u32 s70, s70, s71
    s_lshl_b32 s71, s61, 8
    s_add_u32 s78, s70, s71
    s_add_u32 s79, s78, 131072
    s_mul_i32 s71, s61, 192
    s_add_u32 s70, s70, s71
    s_add_u32 s80, s70, 262144
    v_add_u32 v172, s38, v4
    buffer_load_dwordx4 v4, s[28:31], s89 offen offset:3072 sc1 lds
    s_xor_b32 s71, s54, 1
    s_mul_i32 s71, s71, 3072
    v_add_u32 v173, s71, v4
    s_lshl_b32 s70, s57, 1
    s_add_u32 s70, s70, s55
    s_cmp_ge_u32 s70, 23
    s_cselect_b32 s71, 23, 0
    s_cselect_b32 s72, 344, 0
    s_cselect_b32 s40, 64, 0
    s_sub_u32 s71, s70, s71
    s_mul_i32 s73, s71, 43
    s_lshr_b32 s73, s73, 8
    s_lshl_b32 s73, s73, 3
    s_lshl_b32 s71, s71, 4
    s_sub_u32 s71, s71, s73
    s_add_u32 m0, s86, 0
    s_add_u32 s89, s88, 24576
    buffer_load_dwordx4 v4, s[28:31], s89 offen offset:0 sc1 lds
    s_add_u32 s72, s72, s71
    s_lshl_b32 s71, s56, 3
    s_add_u32 s72, s72, s71
    s_lshl_b32 s72, s72, 10
    s_lshl_b32 s71, s58, 7
    s_add_u32 s36, s72, s71
    s_mul_i32 s41, s58, 94208
    s_add_u32 s41, s41, 3407872
    s_lshl_b32 s71, s70, 11
    s_add_u32 s37, s41, s71
    s_lshl_b32 s71, s56, 9
    s_add_u32 s37, s37, s71
    s_cmp_ge_u32 s70, 46
    s_cselect_b32 s36, 0x40000000, s36
    s_cselect_b32 s37, 0x40000000, s37
    v_lshrrev_b32 v6, 3, v1
    buffer_load_dwordx4 v4, s[28:31], s89 offen offset:1024 sc1 lds
    v_and_b32 v7, 7, v1
    v_lshlrev_b32 v7, 4, v7
    v_lshl_add_u32 v27, v6, 10, v7
    buffer_load_dwordx4 v4, s[28:31], s89 offen offset:2048 sc1 lds
    buffer_load_dwordx4 v4, s[28:31], s89 offen offset:3072 sc1 lds
    s_waitcnt vmcnt(8)
    ds_read2st64_b32 v[224:225], v13 offset0:48 offset1:52
    ds_read2st64_b32 v[226:227], v13 offset0:56 offset1:60
    ds_read2st64_b32 v[228:229], v13 offset0:32 offset1:36
    ds_read2st64_b32 v[230:231], v13 offset0:40 offset1:44
    s_waitcnt lgkmcnt(0)
L_ag_4:
    v_max3_u32 v224, v224, v225, v226
    v_max3_u32 v224, v224, v227, v228
    v_max3_u32 v224, v224, v229, v230
    v_max_u32 v224, v224, v231
    v_cmp_eq_u32 vcc, -1, v224
    s_cbranch_vccnz L_rt_5
L_rc_6:
    s_barrier
    ds_read_b64_tr_b16 v[176:177], v14 offset:12288
    ds_read_b64_tr_b16 v[178:179], v14 offset:12544
    ds_read_b64_tr_b16 v[180:181], v14 offset:13312
    ds_read_b64_tr_b16 v[182:183], v14 offset:13568
    ds_read_b64_tr_b16 v[184:185], v14 offset:14336
    ds_read_b64_tr_b16 v[186:187], v14 offset:14592
    ds_read_b64_tr_b16 v[188:189], v14 offset:15360
    ds_read_b64_tr_b16 v[190:191], v14 offset:15616
    ds_read_b64_tr_b16 v[192:193], v14 offset:28672
    ds_read_b64_tr_b16 v[194:195], v14 offset:28928
    ds_read_b64_tr_b16 v[196:197], v14 offset:29696
    ds_read_b64_tr_b16 v[198:199], v14 offset:29952
    ds_read_b64_tr_b16 v[200:201], v14 offset:30720
    ds_read_b64_tr_b16 v[202:203], v14 offset:30976
    ds_read_b64_tr_b16 v[204:205], v14 offset:31744
    ds_read_b64_tr_b16 v[206:207], v14 offset:32000
    s_waitcnt lgkmcnt(14)
    v_mfma_f32_32x32x16_bf16 v[32:47], v[176:179], v[240:243], v[32:47]
    ds_read_b64_tr_b16 v[208:209], v14 offset:8192
    ds_read_b64_tr_b16 v[210:211], v14 offset:8448
    s_add_u32 s89, s96, 786432
    s_add_u32 m0, s38, 0
    s_nop 0
    buffer_load_dwordx4 v4, s[28:31], s89 offen offset:0 sc1 lds
    s_waitcnt lgkmcnt(14)
    v_mfma_f32_32x32x16_bf16 v[32:47], v[180:183], v[244:247], v[32:47]
    ds_read_b64_tr_b16 v[212:213], v14 offset:9216
    ds_read_b64_tr_b16 v[214:215], v14 offset:9472
    s_waitcnt lgkmcnt(14)
    v_mfma_f32_32x32x16_bf16 v[32:47], v[184:187], v[248:251], v[32:47]
    ds_read_b64_tr_b16 v[216:217], v14 offset:10240
    ds_read_b64_tr_b16 v[218:219], v14 offset:10496
    s_waitcnt lgkmcnt(14)
    v_mfma_f32_32x32x16_bf16 v[32:47], v[188:191], v[252:255], v[32:47]
    ds_read_b64_tr_b16 v[220:221], v14 offset:11264
    ds_read_b64_tr_b16 v[222:223], v14 offset:11520
    buffer_load_dwordx4 v4, s[28:31], s89 offen offset:1024 sc1 lds
    s_waitcnt lgkmcnt(8)
    v_mfma_f32_32x32x16_bf16 v[48:63], v[192:195], v[240:243], v[48:63]
    ds_read_b64_tr_b16 v[176:177], v14 offset:24576
    ds_read_b64_tr_b16 v[178:179], v14 offset:24832
    v_mfma_f32_32x32x16_bf16 v[48:63], v[196:199], v[244:247], v[48:63]
    s_waitcnt vmcnt(2)
    ds_read2st64_b32 v[224:225], v13 offset0:16 offset1:20
    ds_read2st64_b32 v[226:227], v13 offset0:24 offset1:28
    ds_read2st64_b32 v[228:229], v13 offset0:0 offset1:4
    ds_read2st64_b32 v[230:231], v13 offset0:8 offset1:12
    ds_read_b64_tr_b16 v[180:181], v14 offset:25600
    ds_read_b64_tr_b16 v[182:183], v14 offset:25856
    v_mfma_f32_32x32x16_bf16 v[48:63], v[200:203], v[248:251], v[48:63]
    ds_read_b64_tr_b16 v[184:185], v14 offset:26624
    ds_read_b64_tr_b16 v[186:187], v14 offset:26880
    buffer_load_dwordx4 v24, s[28:31], s89 offen offset:2048 sc1 lds
    v_mfma_f32_32x32x16_bf16 v[48:63], v[204:207], v[252:255], v[48:63]
    ds_read_b64_tr_b16 v[188:189], v14 offset:27648
    ds_read_b64_tr_b16 v[190:191], v14 offset:27904
    s_waitcnt lgkmcnt(12)
    v_mfma_f32_32x32x16_bf16 v[64:79], v[208:211], v[240:243], v[64:79]
    s_waitcnt lgkmcnt(6)
L_ag_7:
    v_max3_u32 v224, v224, v225, v226
    v_max3_u32 v224, v224, v227, v228
    v_max3_u32 v224, v224, v229, v230
    v_max_u32 v224, v224, v231
    v_cmp_eq_u32 vcc, -1, v224
    s_cbranch_vccnz L_rt_8
L_rc_9:
    s_barrier
    ds_read_b64_tr_b16 v[192:193], v14 offset:4096
    ds_read_b64_tr_b16 v[194:195], v14 offset:4352
    v_mfma_f32_32x32x16_bf16 v[64:79], v[212:215], v[244:247], v[64:79]
    ds_read_b64_tr_b16 v[196:197], v14 offset:5120
    ds_read_b64_tr_b16 v[198:199], v14 offset:5376
    s_add_u32 s89, s96, 792576
    s_add_u32 m0, s38, 12288
    s_nop 0
    buffer_load_dwordx4 v4, s[28:31], s89 offen offset:0 sc1 lds
    v_mfma_f32_32x32x16_bf16 v[64:79], v[216:219], v[248:251], v[64:79]
    ds_read_b64_tr_b16 v[200:201], v14 offset:6144
    ds_read_b64_tr_b16 v[202:203], v14 offset:6400
    v_mfma_f32_32x32x16_bf16 v[64:79], v[220:223], v[252:255], v[64:79]
    ds_read_b64_tr_b16 v[204:205], v14 offset:7168
    ds_read_b64_tr_b16 v[206:207], v14 offset:7424
    s_waitcnt lgkmcnt(8)
    v_mfma_f32_32x32x16_bf16 v[80:95], v[176:179], v[240:243], v[80:95]
    ds_read_b64_tr_b16 v[208:209], v14 offset:20480
    ds_read_b64_tr_b16 v[210:211], v14 offset:20736
    buffer_load_dwordx4 v4, s[28:31], s89 offen offset:1024 sc1 lds
    v_mfma_f32_32x32x16_bf16 v[80:95], v[180:183], v[244:247], v[80:95]
    ds_read_b64_tr_b16 v[212:213], v14 offset:21504
    ds_read_b64_tr_b16 v[214:215], v14 offset:21760
    v_mfma_f32_32x32x16_bf16 v[80:95], v[184:187], v[248:251], v[80:95]
    ds_read_b64_tr_b16 v[216:217], v14 offset:22528
    ds_read_b64_tr_b16 v[218:219], v14 offset:22784
    v_mfma_f32_32x32x16_bf16 v[80:95], v[188:191], v[252:255], v[80:95]
    ds_read_b64_tr_b16 v[220:221], v14 offset:23552
    ds_read_b64_tr_b16 v[222:223], v14 offset:23808
    buffer_load_dwordx4 v24, s[28:31], s89 offen offset:2048 sc1 lds
    s_waitcnt lgkmcnt(8)
    v_mfma_f32_32x32x16_bf16 v[96:111], v[192:195], v[240:243], v[96:111]
    ds_read_b64_tr_b16 v[176:177], v14 offset:0
    ds_read_b64_tr_b16 v[178:179], v14 offset:256
    v_mfma_f32_32x32x16_bf16 v[96:111], v[196:199], v[244:247], v[96:111]
    ds_read_b64_tr_b16 v[180:181], v14 offset:1024
    ds_read_b64_tr_b16 v[182:183], v14 offset:1280
    v_mfma_f32_32x32x16_bf16 v[96:111], v[200:203], v[248:251], v[96:111]
    ds_read_b64_tr_b16 v[184:185], v14 offset:2048
    ds_read_b64_tr_b16 v[186:187], v14 offset:2304
    s_add_u32 s89, s96, 798720
    s_add_u32 m0, s38, 24576
    s_nop 0
    buffer_load_dwordx4 v4, s[28:31], s89 offen offset:0 sc1 lds
    v_mfma_f32_32x32x16_bf16 v[96:111], v[204:207], v[252:255], v[96:111]
    ds_read_b64_tr_b16 v[188:189], v14 offset:3072
    ds_read_b64_tr_b16 v[190:191], v14 offset:3328
    s_waitcnt lgkmcnt(8)
    v_mfma_f32_32x32x16_bf16 v[112:127], v[208:211], v[240:243], v[112:127]
    ds_read_b64_tr_b16 v[192:193], v14 offset:16384
    ds_read_b64_tr_b16 v[194:195], v14 offset:16640
    v_mfma_f32_32x32x16_bf16 v[112:127], v[212:215], v[244:247], v[112:127]
    ds_read_b64_tr_b16 v[196:197], v14 offset:17408
    ds_read_b64_tr_b16 v[198:199], v14 offset:17664
    buffer_load_dwordx4 v4, s[28:31], s89 offen offset:1024 sc1 lds
    v_mfma_f32_32x32x16_bf16 v[112:127], v[216:219], v[248:251], v[112:127]
    ds_read_b64_tr_b16 v[200:201], v14 offset:18432
    ds_read_b64_tr_b16 v[202:203], v14 offset:18688
    v_mfma_f32_32x32x16_bf16 v[112:127], v[220:223], v[252:255], v[112:127]
    ds_read_b64_tr_b16 v[204:205], v14 offset:19456
    ds_read_b64_tr_b16 v[206:207], v14 offset:19712
    s_waitcnt lgkmcnt(8)
    v_mfma_f32_32x32x16_bf16 v[128:143], v[176:179], v[240:243], v[128:143]
    buffer_load_dwordx4 v24, s[28:31], s89 offen offset:2048 sc1 lds
    v_cndmask_b32 v32, v32, v29, s[92:93]
    v_add_f32 v164, v164, v32
    v_add_f32 v165, v165, v33
    v_add_f32 v164, v164, v34
    v_add_f32 v165, v165, v35
    v_mfma_f32_32x32x16_bf16 v[128:143], v[180:183], v[244:247], v[128:143]
    v_add_f32 v164, v164, v36
    v_add_f32 v165, v165, v37
    v_add_f32 v164, v164, v38
    v_add_f32 v165, v165, v39
    v_add_f32 v164, v164, v40
    v_mfma_f32_32x32x16_bf16 v[128:143], v[184:187], v[248:251], v[128:143]
    v_add_f32 v165, v165, v41
    v_add_f32 v164, v164, v42
    v_add_f32 v165, v165, v43
    v_add_f32 v164, v164, v44
    v_add_f32 v165, v165, v45
    v_mfma_f32_32x32x16_bf16 v[128:143], v[188:191], v[252:255], v[128:143]
    s_add_u32 s89, s96, 804864
    s_add_u32 m0, s38, 36864
    s_nop 0
    buffer_load_dwordx4 v4, s[28:31], s89 offen offset:0 sc1 lds
    v_add_f32 v164, v164, v46
    v_add_f32 v165, v165, v47
    v_add_f32 v164, v164, v48
    v_add_f32 v165, v165, v49
    v_add_f32 v164, v164, v50
    s_waitcnt lgkmcnt(0)
    v_mfma_f32_32x32x16_bf16 v[144:159], v[192:195], v[240:243], v[144:159]
    v_add_f32 v165, v165, v51
    v_add_f32 v164, v164, v52
    v_add_f32 v165, v165, v53
    v_add_f32 v164, v164, v54
    v_add_f32 v165, v165, v55
    v_mfma_f32_32x32x16_bf16 v[144:159], v[196:199], v[244:247], v[144:159]
    v_add_f32 v164, v164, v56
    v_add_f32 v165, v165, v57
    v_add_f32 v164, v164, v58
    v_add_f32 v165, v165, v59
    v_add_f32 v164, v164, v60
    v_mfma_f32_32x32x16_bf16 v[144:159], v[200:203], v[248:251], v[144:159]
    buffer_load_dwordx4 v4, s[28:31], s89 offen offset:1024 sc1 lds
    v_add_f32 v165, v165, v61
    v_add_f32 v164, v164, v62
    v_add_f32 v165, v165, v63
    v_add_f32 v164, v164, v64
    v_add_f32 v165, v165, v65
    v_mfma_f32_32x32x16_bf16 v[144:159], v[204:207], v[252:255], v[144:159]
    v_add_f32 v164, v164, v66
    v_add_f32 v165, v165, v67
    v_add_f32 v164, v164, v68
    v_add_f32 v165, v165, v69
    v_add_f32 v164, v164, v70
    v_add_f32 v165, v165, v71
    buffer_load_dwordx4 v24, s[28:31], s89 offen offset:2048 sc1 lds
    v_pk_fma_f32 v[166:167], v[32:33], v[32:33], v[166:167]
    v_pk_fma_f32 v[166:167], v[34:35], v[34:35], v[166:167]
    v_pk_fma_f32 v[166:167], v[36:37], v[36:37], v[166:167]
    v_pk_fma_f32 v[166:167], v[38:39], v[38:39], v[166:167]
    v_pk_fma_f32 v[166:167], v[40:41], v[40:41], v[166:167]
    v_pk_fma_f32 v[166:167], v[42:43], v[42:43], v[166:167]
    v_pk_fma_f32 v[166:167], v[44:45], v[44:45], v[166:167]
    v_pk_fma_f32 v[166:167], v[46:47], v[46:47], v[166:167]
    v_pk_fma_f32 v[166:167], v[48:49], v[48:49], v[166:167]
    v_pk_fma_f32 v[166:167], v[50:51], v[50:51], v[166:167]
    v_pk_fma_f32 v[166:167], v[52:53], v[52:53], v[166:167]
    v_pk_fma_f32 v[166:167], v[54:55], v[54:55], v[166:167]
    v_pk_fma_f32 v[166:167], v[56:57], v[56:57], v[166:167]
    v_pk_fma_f32 v[166:167], v[58:59], v[58:59], v[166:167]
    v_pk_fma_f32 v[166:167], v[60:61], v[60:61], v[166:167]
    s_add_u32 s89, s96, 811008
    s_add_u32 m0, s38, 49152
    s_nop 0
    buffer_load_dwordx4 v4, s[28:31], s89 offen offset:0 sc1 lds
    v_pk_fma_f32 v[166:167], v[62:63], v[62:63], v[166:167]
    v_pk_fma_f32 v[166:167], v[64:65], v[64:65], v[166:167]
    v_pk_fma_f32 v[166:167], v[66:67], v[66:67], v[166:167]
    v_pk_fma_f32 v[166:167], v[68:69], v[68:69], v[166:167]
    v_pk_fma_f32 v[166:167], v[70:71], v[70:71], v[166:167]
    v_pk_add_f32 v[164:165], v[164:165], v[72:73]
    v_pk_fma_f32 v[166:167], v[72:73], v[72:73], v[166:167]
    v_pk_add_f32 v[164:165], v[164:165], v[74:75]
    v_pk_fma_f32 v[166:167], v[74:75], v[74:75], v[166:167]
    v_pk_add_f32 v[164:165], v[164:165], v[76:77]
    v_pk_fma_f32 v[166:167], v[76:77], v[76:77], v[166:167]
    v_pk_add_f32 v[164:165], v[164:165], v[78:79]
    v_pk_fma_f32 v[166:167], v[78:79], v[78:79], v[166:167]
    buffer_load_dwordx4 v4, s[28:31], s89 offen offset:1024 sc1 lds
    v_pk_add_f32 v[164:165], v[164:165], v[80:81]
    v_pk_fma_f32 v[166:167], v[80:81], v[80:81], v[166:167]
    v_pk_add_f32 v[164:165], v[164:165], v[82:83]
    v_pk_fma_f32 v[166:167], v[82:83], v[82:83], v[166:167]
    v_pk_add_f32 v[164:165], v[164:165], v[84:85]
    v_pk_fma_f32 v[166:167], v[84:85], v[84:85], v[166:167]
    v_pk_add_f32 v[164:165], v[164:165], v[86:87]
    v_pk_fma_f32 v[166:167], v[86:87], v[86:87], v[166:167]
    v_pk_add_f32 v[164:165], v[164:165], v[88:89]
    v_pk_fma_f32 v[166:167], v[88:89], v[88:89], v[166:167]
    v_pk_add_f32 v[164:165], v[164:165], v[90:91]
    v_pk_fma_f32 v[166:167], v[90:91], v[90:91], v[166:167]
    v_pk_add_f32 v[164:165], v[164:165], v[92:93]
    v_pk_fma_f32 v[166:167], v[92:93], v[92:93], v[166:167]
    v_pk_add_f32 v[164:165], v[164:165], v[94:95]
    buffer_load_dwordx4 v24, s[28:31], s89 offen offset:2048 sc1 lds
    v_pk_fma_f32 v[166:167], v[94:95], v[94:95], v[166:167]
    v_pk_add_f32 v[164:165], v[164:165], v[96:97]
    v_pk_fma_f32 v[166:167], v[96:97], v[96:97], v[166:167]
    v_pk_add_f32 v[164:165], v[164:165], v[98:99]
    v_pk_fma_f32 v[166:167], v[98:99], v[98:99], v[166:167]
    v_pk_add_f32 v[164:165], v[164:165], v[100:101]
    v_pk_fma_f32 v[166:167], v[100:101], v[100:101], v[166:167]
    v_pk_add_f32 v[164:165], v[164:165], v[102:103]
    v_pk_fma_f32 v[166:167], v[102:103], v[102:103], v[166:167]
    v_pk_add_f32 v[164:165], v[164:165], v[104:105]
    v_pk_fma_f32 v[166:167], v[104:105], v[104:105], v[166:167]
    v_pk_add_f32 v[164:165], v[164:165], v[106:107]
    v_pk_fma_f32 v[166:167], v[106:107], v[106:107], v[166:167]
    v_pk_add_f32 v[164:165], v[164:165], v[108:109]
    v_pk_fma_f32 v[166:167], v[108:109], v[108:109], v[166:167]
    s_add_u32 s89, s96, 817152
    s_add_u32 m0, s38, 61440
    s_nop 0
    buffer_load_dwordx4 v4, s[28:31], s89 offen offset:0 sc1 lds
    v_pk_add_f32 v[164:165], v[164:165], v[110:111]
    v_pk_fma_f32 v[166:167], v[110:111], v[110:111], v[166:167]
    v_pk_add_f32 v[164:165], v[164:165], v[112:113]
    v_pk_fma_f32 v[166:167], v[112:113], v[112:113], v[166:167]
    v_pk_add_f32 v[164:165], v[164:165], v[114:115]
    v_pk_fma_f32 v[166:167], v[114:115], v[114:115], v[166:167]
    v_pk_add_f32 v[164:165], v[164:165], v[116:117]
    v_pk_fma_f32 v[166:167], v[116:117], v[116:117], v[166:167]
    v_pk_add_f32 v[164:165], v[164:165], v[118:119]
    v_pk_fma_f32 v[166:167], v[118:119], v[118:119], v[166:167]
    v_pk_add_f32 v[164:165], v[164:165], v[120:121]
    v_pk_fma_f32 v[166:167], v[120:121], v[120:121], v[166:167]
    v_pk_add_f32 v[164:165], v[164:165], v[122:123]
    buffer_load_dwordx4 v4, s[28:31], s89 offen offset:1024 sc1 lds
    v_pk_fma_f32 v[166:167], v[122:123], v[122:123], v[166:167]
    v_pk_add_f32 v[164:165], v[164:165], v[124:125]
    v_pk_fma_f32 v[166:167], v[124:125], v[124:125], v[166:167]
    v_pk_add_f32 v[164:165], v[164:165], v[126:127]
    v_pk_fma_f32 v[166:167], v[126:127], v[126:127], v[166:167]
    v_pk_add_f32 v[164:165], v[164:165], v[128:129]
    v_pk_fma_f32 v[166:167], v[128:129], v[128:129], v[166:167]
    v_pk_add_f32 v[164:165], v[164:165], v[130:131]
    v_pk_fma_f32 v[166:167], v[130:131], v[130:131], v[166:167]
    v_pk_add_f32 v[164:165], v[164:165], v[132:133]
    v_pk_fma_f32 v[166:167], v[132:133], v[132:133], v[166:167]
    v_pk_add_f32 v[164:165], v[164:165], v[134:135]
    v_pk_fma_f32 v[166:167], v[134:135], v[134:135], v[166:167]
    v_pk_add_f32 v[164:165], v[164:165], v[136:137]
    v_pk_fma_f32 v[166:167], v[136:137], v[136:137], v[166:167]
    buffer_load_dwordx4 v24, s[28:31], s89 offen offset:2048 sc1 lds
    v_pk_add_f32 v[164:165], v[164:165], v[138:139]
    v_pk_fma_f32 v[166:167], v[138:139], v[138:139], v[166:167]
    v_pk_add_f32 v[164:165], v[164:165], v[140:141]
    v_pk_fma_f32 v[166:167], v[140:141], v[140:141], v[166:167]
    v_pk_add_f32 v[164:165], v[164:165], v[142:143]
    v_pk_fma_f32 v[166:167], v[142:143], v[142:143], v[166:167]
    v_pk_add_f32 v[164:165], v[164:165], v[144:145]
    v_pk_fma_f32 v[166:167], v[144:145], v[144:145], v[166:167]
    v_pk_add_f32 v[164:165], v[164:165], v[146:147]
    v_pk_fma_f32 v[166:167], v[146:147], v[146:147], v[166:167]
    v_pk_add_f32 v[164:165], v[164:165], v[148:149]
    v_pk_fma_f32 v[166:167], v[148:149], v[148:149], v[166:167]
    v_pk_add_f32 v[164:165], v[164:165], v[150:151]
    v_pk_fma_f32 v[166:167], v[150:151], v[150:151], v[166:167]
    v_pk_add_f32 v[164:165], v[164:165], v[152:153]
    s_add_u32 s89, s96, 823296
    s_add_u32 m0, s38, 73728
    s_nop 0
    buffer_load_dwordx4 v4, s[28:31], s89 offen offset:0 sc1 lds
    v_pk_fma_f32 v[166:167], v[152:153], v[152:153], v[166:167]
    v_pk_add_f32 v[164:165], v[164:165], v[154:155]
    v_pk_fma_f32 v[166:167], v[154:155], v[154:155], v[166:167]
    v_pk_add_f32 v[164:165], v[164:165], v[156:157]
    v_pk_fma_f32 v[166:167], v[156:157], v[156:157], v[166:167]
    v_pk_add_f32 v[164:165], v[164:165], v[158:159]
    v_pk_fma_f32 v[166:167], v[158:159], v[158:159], v[166:167]
    v_add_f32 v164, v164, v165
    v_add_f32 v166, v166, v167
    s_nop 1
    v_permlane32_swap_b32 v164, v166
    v_add_f32 v164, v164, v166
    ds_write_b32 v15, v164
    s_waitcnt lgkmcnt(0)
    s_waitcnt vmcnt(13)
    s_barrier
    ds_read2_b32 v[164:165], v16 offset0:0 offset1:64
    ds_read2_b32 v[166:167], v16 offset0:32 offset1:96
    ds_read_b128 v[176:179], v28 offset:0
    ds_read_b128 v[180:183], v28 offset:1024
    ds_read_b128 v[184:187], v28 offset:2048
    ds_read_b128 v[188:191], v28 offset:6144
    ds_read_b128 v[192:195], v28 offset:7168
    ds_read_b128 v[196:199], v28 offset:8192
    s_waitcnt lgkmcnt(7)
    v_add_f32 v164, v164, v165
    s_waitcnt lgkmcnt(6)
    v_add_f32 v166, v166, v167
    v_mul_f32 v168, 0x3b000000, v164
    v_mul_f32 v30, 0x3b000000, v166
    v_fma_f32 v30, -v168, v168, v30
    v_max_f32 v30, 0, v30
    v_add_f32 v30, 0x3727c5ac, v30
    v_mov_b32 v169, v30
    v_rsq_f32 v30, v30
    s_nop 0
    v_mul_f32 v170, v168, v30
    v_sub_f32 v170, 0, v170
    v_pk_fma_f32 v[32:33], v[32:33], v[30:31], v[170:171] op_sel_hi:[1,0,0]
    v_pk_fma_f32 v[34:35], v[34:35], v[30:31], v[170:171] op_sel_hi:[1,0,0]
    v_pk_fma_f32 v[36:37], v[36:37], v[30:31], v[170:171] op_sel_hi:[1,0,0]
    v_pk_fma_f32 v[38:39], v[38:39], v[30:31], v[170:171] op_sel_hi:[1,0,0]
    v_cvt_pk_bf16_f32 v32, v32, v33
    v_cvt_pk_bf16_f32 v33, v34, v35
    v_cvt_pk_bf16_f32 v34, v36, v37
    v_cvt_pk_bf16_f32 v35, v38, v39
    s_waitcnt lgkmcnt(3)
    s_nop 0
    v_mfma_f32_32x32x16_bf16 v[208:223], v[176:179], v[32:35], 0
    ds_read_b128 v[176:179], v28 offset:12288
    v_fma_f32 v40, v40, v30, v170
    v_fma_f32 v41, v41, v30, v170
    v_cvt_pk_bf16_f32 v36, v40, v41
    v_fma_f32 v42, v42, v30, v170
    v_fma_f32 v43, v43, v30, v170
    v_mov_b32 v162, 0x3f80
    v_lshrrev_b32 v161, 4, v1
    v_add_u32 v26, 1, v161
    v_lshrrev_b32 v26, 2, v26
    v_lshl_add_u32 v161, v161, 8, v4
    v_lshl_add_u32 v26, v26, 30, v161
    v_add_u32 v29, 98304, v28
    s_lshl_b32 s7, s54, 13
    s_add_u32 s7, s7, 65536
    s_sub_u32 s70, s86, s7
    v_subrev_u32 v171, s70, v17
    v_add_u32 v17, 65536, v171
    s_lshl_b32 s70, s54, 12
    s_add_u32 s70, s70, 16384
    v_subrev_u32 v15, s70, v171
    v_xor_b32 v200, 0, v171
    v_xor_b32 v201, 32, v171
    v_xor_b32 v202, 64, v171
    v_xor_b32 v203, 96, v171
    v_xor_b32 v204, 0, v17
    v_xor_b32 v205, 32, v17
    v_xor_b32 v206, 64, v17
    v_xor_b32 v207, 96, v17
    v_mfma_f32_32x32x16_bf16 v[224:239], v[180:183], v[32:35], 0
    ds_read_b128 v[180:183], v28 offset:13312
    v_cvt_pk_bf16_f32 v37, v42, v43
    v_fma_f32 v44, v44, v30, v170
    v_fma_f32 v45, v45, v30, v170
    v_cvt_pk_bf16_f32 v38, v44, v45
    v_fma_f32 v46, v46, v30, v170
    buffer_load_dwordx4 v4, s[28:31], s89 offen offset:1024 sc1 lds
    v_mfma_f32_32x32x16_bf16 v[240:255], v[184:187], v[32:35], 0
    ds_read_b128 v[184:187], v28 offset:14336
    v_fma_f32 v47, v47, v30, v170
    v_cvt_pk_bf16_f32 v39, v46, v47
    v_fma_f32 v48, v48, v30, v170
    v_fma_f32 v49, v49, v30, v170
    v_cvt_pk_bf16_f32 v40, v48, v49
    s_waitcnt lgkmcnt(3)
    v_mfma_f32_32x32x16_bf16 v[208:223], v[188:191], v[36:39], v[208:223]
    ds_read_b128 v[188:191], v28 offset:18432
    v_fma_f32 v50, v50, v30, v170
    v_fma_f32 v51, v51, v30, v170
    v_cvt_pk_bf16_f32 v41, v50, v51
    v_fma_f32 v52, v52, v30, v170
    v_fma_f32 v53, v53, v30, v170
    buffer_load_dwordx4 v24, s[28:31], s89 offen offset:2048 sc1 lds
    v_mfma_f32_32x32x16_bf16 v[224:239], v[192:195], v[36:39], v[224:239]
    ds_read_b128 v[192:195], v28 offset:19456
    v_cvt_pk_bf16_f32 v42, v52, v53
    v_fma_f32 v54, v54, v30, v170
    v_fma_f32 v55, v55, v30, v170
    v_cvt_pk_bf16_f32 v43, v54, v55
    v_fma_f32 v56, v56, v30, v170
    s_add_u32 s89, s96, 829440
    s_add_u32 m0, s38, 86016
    s_nop 0
    buffer_load_dwordx4 v4, s[28:31], s89 offen offset:0 sc1 lds
    v_mfma_f32_32x32x16_bf16 v[240:255], v[196:199], v[36:39], v[240:255]
    ds_read_b128 v[196:199], v28 offset:20480
    v_fma_f32 v57, v57, v30, v170
    v_cvt_pk_bf16_f32 v44, v56, v57
    v_fma_f32 v58, v58, v30, v170
    v_fma_f32 v59, v59, v30, v170
    v_cvt_pk_bf16_f32 v45, v58, v59
    s_waitcnt vmcnt(10)
    s_barrier
    s_waitcnt lgkmcnt(3)
    v_mfma_f32_32x32x16_bf16 v[208:223], v[176:179], v[40:43], v[208:223]
    ds_read_b128 v[176:179], v28 offset:24576
    v_fma_f32 v60, v60, v30, v170
    v_fma_f32 v61, v61, v30, v170
    v_cvt_pk_bf16_f32 v46, v60, v61
    v_fma_f32 v62, v62, v30, v170
    v_fma_f32 v63, v63, v30, v170
    buffer_load_dwordx4 v4, s[28:31], s89 offen offset:1024 sc1 lds
    v_mfma_f32_32x32x16_bf16 v[224:239], v[180:183], v[40:43], v[224:239]
    ds_read_b128 v[180:183], v28 offset:25600
    v_cvt_pk_bf16_f32 v47, v62, v63
    v_fma_f32 v64, v64, v30, v170
    v_fma_f32 v65, v65, v30, v170
    v_cvt_pk_bf16_f32 v48, v64, v65
    v_fma_f32 v66, v66, v30, v170
    v_mfma_f32_32x32x16_bf16 v[240:255], v[184:187], v[40:43], v[240:255]
    ds_read_b128 v[184:187], v28 offset:26624
    v_fma_f32 v67, v67, v30, v170
    v_cvt_pk_bf16_f32 v49, v66, v67
    v_fma_f32 v68, v68, v30, v170
    v_fma_f32 v69, v69, v30, v170
    v_cvt_pk_bf16_f32 v50, v68, v69
    buffer_load_dwordx4 v24, s[28:31], s89 offen offset:2048 sc1 lds
    s_waitcnt lgkmcnt(3)
    v_mfma_f32_32x32x16_bf16 v[208:223], v[188:191], v[44:47], v[208:223]
    ds_read_b128 v[188:191], v28 offset:30720
    v_fma_f32 v70, v70, v30, v170
    v_fma_f32 v71, v71, v30, v170
    v_cvt_pk_bf16_f32 v51, v70, v71
    v_fma_f32 v72, v72, v30, v170
    v_fma_f32 v73, v73, v30, v170
    v_mfma_f32_32x32x16_bf16 v[224:239], v[192:195], v[44:47], v[224:239]
    ds_read_b128 v[192:195], v28 offset:31744
    v_cvt_pk_bf16_f32 v52, v72, v73
    v_fma_f32 v74, v74, v30, v170
    v_fma_f32 v75, v75, v30, v170
    v_cvt_pk_bf16_f32 v53, v74, v75
    v_fma_f32 v76, v76, v30, v170
    v_mfma_f32_32x32x16_bf16 v[240:255], v[196:199], v[44:47], v[240:255]
    ds_read_b128 v[196:199], v28 offset:32768
    v_fma_f32 v77, v77, v30, v170
    v_cvt_pk_bf16_f32 v54, v76, v77
    v_fma_f32 v78, v78, v30, v170
    v_fma_f32 v79, v79, v30, v170
    v_cvt_pk_bf16_f32 v55, v78, v79
    s_waitcnt lgkmcnt(3)
    v_mfma_f32_32x32x16_bf16 v[208:223], v[176:179], v[48:51], v[208:223]
    ds_read_b128 v[176:179], v28 offset:36864
    v_fma_f32 v80, v80, v30, v170
    v_fma_f32 v81, v81, v30, v170
    v_cvt_pk_bf16_f32 v56, v80, v81
    v_fma_f32 v82, v82, v30, v170
    s_add_u32 s89, s96, 12288
    s_add_u32 m0, s38, 122880
    s_nop 0
    buffer_load_dwordx4 v4, s[28:31], s89 offen offset:0 sc1 lds
    v_mfma_f32_32x32x16_bf16 v[224:239], v[180:183], v[48:51], v[224:239]
    ds_read_b128 v[180:183], v28 offset:37888
    v_fma_f32 v83, v83, v30, v170
    v_cvt_pk_bf16_f32 v57, v82, v83
    v_fma_f32 v84, v84, v30, v170
    v_fma_f32 v85, v85, v30, v170
    buffer_load_dwordx4 v4, s[28:31], s89 offen offset:1024 sc1 lds
    v_mfma_f32_32x32x16_bf16 v[240:255], v[184:187], v[48:51], v[240:255]
    ds_read_b128 v[184:187], v28 offset:38912
    v_cvt_pk_bf16_f32 v58, v84, v85
    v_fma_f32 v86, v86, v30, v170
    v_fma_f32 v87, v87, v30, v170
    v_cvt_pk_bf16_f32 v59, v86, v87
    s_waitcnt lgkmcnt(3)
    v_mfma_f32_32x32x16_bf16 v[208:223], v[188:191], v[52:55], v[208:223]
    ds_read_b128 v[188:191], v28 offset:43008
    v_fma_f32 v88, v88, v30, v170
    v_fma_f32 v89, v89, v30, v170
    v_cvt_pk_bf16_f32 v60, v88, v89
    v_fma_f32 v90, v90, v30, v170
    buffer_load_dwordx4 v24, s[28:31], s89 offen offset:2048 sc1 lds
    v_mfma_f32_32x32x16_bf16 v[224:239], v[192:195], v[52:55], v[224:239]
    ds_read_b128 v[192:195], v28 offset:44032
    v_fma_f32 v91, v91, v30, v170
    v_cvt_pk_bf16_f32 v61, v90, v91
    v_fma_f32 v92, v92, v30, v170
    v_fma_f32 v93, v93, v30, v170
    s_add_u32 s89, s96, 0
    s_add_u32 m0, s38, 98304
    s_nop 0
    buffer_load_dwordx4 v4, s[28:31], s89 offen offset:0 sc1 lds
    v_mfma_f32_32x32x16_bf16 v[240:255], v[196:199], v[52:55], v[240:255]
    ds_read_b128 v[196:199], v28 offset:45056
    v_cvt_pk_bf16_f32 v62, v92, v93
    v_fma_f32 v94, v94, v30, v170
    v_fma_f32 v95, v95, v30, v170
    v_cvt_pk_bf16_f32 v63, v94, v95
    s_waitcnt vmcnt(10)
    s_barrier
    s_waitcnt lgkmcnt(3)
    v_mfma_f32_32x32x16_bf16 v[208:223], v[176:179], v[56:59], v[208:223]
    ds_read_b128 v[176:179], v25 offset:0
    v_fma_f32 v96, v96, v30, v170
    v_fma_f32 v97, v97, v30, v170
    v_cvt_pk_bf16_f32 v64, v96, v97
    v_fma_f32 v98, v98, v30, v170
    buffer_load_dwordx4 v4, s[28:31], s89 offen offset:1024 sc1 lds
    v_mfma_f32_32x32x16_bf16 v[224:239], v[180:183], v[56:59], v[224:239]
    ds_read_b128 v[180:183], v25 offset:1024
    v_fma_f32 v99, v99, v30, v170
    v_cvt_pk_bf16_f32 v65, v98, v99
    v_fma_f32 v100, v100, v30, v170
    v_fma_f32 v101, v101, v30, v170
    v_mfma_f32_32x32x16_bf16 v[240:255], v[184:187], v[56:59], v[240:255]
    ds_read_b128 v[184:187], v25 offset:2048
    v_cvt_pk_bf16_f32 v66, v100, v101
    v_fma_f32 v102, v102, v30, v170
    v_fma_f32 v103, v103, v30, v170
    v_cvt_pk_bf16_f32 v67, v102, v103
    buffer_load_dwordx4 v24, s[28:31], s89 offen offset:2048 sc1 lds
    s_waitcnt lgkmcnt(3)
    v_mfma_f32_32x32x16_bf16 v[208:223], v[188:191], v[60:63], v[208:223]
    ds_read_b128 v[188:191], v25 offset:6144
    v_fma_f32 v104, v104, v30, v170
    v_fma_f32 v105, v105, v30, v170
    v_cvt_pk_bf16_f32 v68, v104, v105
    v_fma_f32 v106, v106, v30, v170
    v_mfma_f32_32x32x16_bf16 v[224:239], v[192:195], v[60:63], v[224:239]
    ds_read_b128 v[192:195], v25 offset:7168
    v_fma_f32 v107, v107, v30, v170
    v_cvt_pk_bf16_f32 v69, v106, v107
    v_fma_f32 v108, v108, v30, v170
    v_fma_f32 v109, v109, v30, v170
    s_add_u32 s89, s96, 24576
    s_add_u32 m0, s38, 147456
    s_nop 0
    buffer_load_dwordx4 v4, s[28:31], s89 offen offset:0 sc1 lds
    v_mfma_f32_32x32x16_bf16 v[240:255], v[196:199], v[60:63], v[240:255]
    ds_read_b128 v[196:199], v25 offset:8192
    v_cvt_pk_bf16_f32 v70, v108, v109
    v_fma_f32 v110, v110, v30, v170
    v_fma_f32 v111, v111, v30, v170
    v_cvt_pk_bf16_f32 v71, v110, v111
    buffer_load_dwordx4 v4, s[28:31], s89 offen offset:1024 sc1 lds
    s_waitcnt lgkmcnt(3)
    v_mfma_f32_32x32x16_bf16 v[208:223], v[176:179], v[64:67], v[208:223]
    ds_read_b128 v[176:179], v25 offset:12288
    v_fma_f32 v112, v112, v30, v170
    v_fma_f32 v113, v113, v30, v170
    v_cvt_pk_bf16_f32 v72, v112, v113
    v_fma_f32 v114, v114, v30, v170
    v_mfma_f32_32x32x16_bf16 v[224:239], v[180:183], v[64:67], v[224:239]
    ds_read_b128 v[180:183], v25 offset:13312
    v_fma_f32 v115, v115, v30, v170
    v_cvt_pk_bf16_f32 v73, v114, v115
    v_fma_f32 v116, v116, v30, v170
    v_fma_f32 v117, v117, v30, v170
    buffer_load_dwordx4 v24, s[28:31], s89 offen offset:2048 sc1 lds
    v_mfma_f32_32x32x16_bf16 v[240:255], v[184:187], v[64:67], v[240:255]
    ds_read_b128 v[184:187], v25 offset:14336
    v_cvt_pk_bf16_f32 v74, v116, v117
    v_fma_f32 v118, v118, v30, v170
    v_fma_f32 v119, v119, v30, v170
    v_cvt_pk_bf16_f32 v75, v118, v119
    s_add_u32 s89, s96, 36864
    s_add_u32 m0, s38, 12288
    s_nop 0
    buffer_load_dwordx4 v4, s[28:31], s89 offen offset:0 sc1 lds
    s_waitcnt lgkmcnt(3)
    v_mfma_f32_32x32x16_bf16 v[208:223], v[188:191], v[68:71], v[208:223]
    ds_read_b128 v[188:191], v25 offset:18432
    v_fma_f32 v120, v120, v30, v170
    v_fma_f32 v121, v121, v30, v170
    v_cvt_pk_bf16_f32 v76, v120, v121
    v_fma_f32 v122, v122, v30, v170
    v_mfma_f32_32x32x16_bf16 v[224:239], v[192:195], v[68:71], v[224:239]
    ds_read_b128 v[192:195], v25 offset:19456
    v_fma_f32 v123, v123, v30, v170
    v_cvt_pk_bf16_f32 v77, v122, v123
    v_fma_f32 v124, v124, v30, v170
    v_fma_f32 v125, v125, v30, v170
    buffer_load_dwordx4 v4, s[28:31], s89 offen offset:1024 sc1 lds
    v_mfma_f32_32x32x16_bf16 v[240:255], v[196:199], v[68:71], v[240:255]
    ds_read_b128 v[196:199], v25 offset:20480
    v_cvt_pk_bf16_f32 v78, v124, v125
    v_fma_f32 v126, v126, v30, v170
    v_fma_f32 v127, v127, v30, v170
    v_cvt_pk_bf16_f32 v79, v126, v127
    s_waitcnt vmcnt(11)
    s_barrier
    s_waitcnt lgkmcnt(3)
    v_mfma_f32_32x32x16_bf16 v[208:223], v[176:179], v[72:75], v[208:223]
    ds_read_b128 v[176:179], v25 offset:24576
    v_fma_f32 v128, v128, v30, v170
    v_fma_f32 v129, v129, v30, v170
    v_cvt_pk_bf16_f32 v80, v128, v129
    v_fma_f32 v130, v130, v30, v170
    buffer_load_dwordx4 v24, s[28:31], s89 offen offset:2048 sc1 lds
    v_mfma_f32_32x32x16_bf16 v[224:239], v[180:183], v[72:75], v[224:239]
    ds_read_b128 v[180:183], v25 offset:25600
    v_fma_f32 v131, v131, v30, v170
    v_cvt_pk_bf16_f32 v81, v130, v131
    v_fma_f32 v132, v132, v30, v170
    v_fma_f32 v133, v133, v30, v170
    s_or_b32 s90, s2, s54
    s_cmp_eq_u32 s90, 0
    s_cselect_b32 s90, 0, 0x40000000
    v_mov_b32 v9, s90
    s_mov_b64 exec, 1
    buffer_store_dword v31, v9, s[28:31], 0 offen sc1
    s_mov_b64 exec, -1
    v_mfma_f32_32x32x16_bf16 v[240:255], v[184:187], v[72:75], v[240:255]
    ds_read_b128 v[184:187], v25 offset:26624
    v_cvt_pk_bf16_f32 v82, v132, v133
    v_fma_f32 v134, v134, v30, v170
    v_fma_f32 v135, v135, v30, v170
    v_cvt_pk_bf16_f32 v83, v134, v135
    s_waitcnt lgkmcnt(3)
    v_mfma_f32_32x32x16_bf16 v[208:223], v[188:191], v[76:79], v[208:223]
    ds_read_b128 v[188:191], v25 offset:30720
    v_fma_f32 v136, v136, v30, v170
    v_fma_f32 v137, v137, v30, v170
    v_cvt_pk_bf16_f32 v84, v136, v137
    v_fma_f32 v138, v138, v30, v170
    s_add_u32 s89, s96, 30720
    s_add_u32 m0, s38, 0
    s_nop 0
    buffer_load_dwordx4 v4, s[28:31], s89 offen offset:0 sc1 lds
    v_mfma_f32_32x32x16_bf16 v[224:239], v[192:195], v[76:79], v[224:239]
    ds_read_b128 v[192:195], v25 offset:31744
    v_fma_f32 v139, v139, v30, v170
    v_cvt_pk_bf16_f32 v85, v138, v139
    v_fma_f32 v140, v140, v30, v170
    v_fma_f32 v141, v141, v30, v170
    buffer_load_dwordx4 v4, s[28:31], s89 offen offset:1024 sc1 lds
    v_mfma_f32_32x32x16_bf16 v[240:255], v[196:199], v[76:79], v[240:255]
    ds_read_b128 v[196:199], v25 offset:32768
    v_cvt_pk_bf16_f32 v86, v140, v141
    v_fma_f32 v142, v142, v30, v170
    v_fma_f32 v143, v143, v30, v170
    v_cvt_pk_bf16_f32 v87, v142, v143
    s_waitcnt lgkmcnt(3)
    v_mfma_f32_32x32x16_bf16 v[208:223], v[176:179], v[80:83], v[208:223]
    ds_read_b128 v[176:179], v25 offset:36864
    v_fma_f32 v144, v144, v30, v170
    v_fma_f32 v145, v145, v30, v170
    v_cvt_pk_bf16_f32 v88, v144, v145
    v_fma_f32 v146, v146, v30, v170
    buffer_load_dwordx4 v24, s[28:31], s89 offen offset:2048 sc1 lds
    v_mfma_f32_32x32x16_bf16 v[224:239], v[180:183], v[80:83], v[224:239]
    ds_read_b128 v[180:183], v25 offset:37888
    v_fma_f32 v147, v147, v30, v170
    v_cvt_pk_bf16_f32 v89, v146, v147
    v_fma_f32 v148, v148, v30, v170
    v_fma_f32 v149, v149, v30, v170
    v_mfma_f32_32x32x16_bf16 v[240:255], v[184:187], v[80:83], v[240:255]
    ds_read_b128 v[184:187], v25 offset:38912
    v_cvt_pk_bf16_f32 v90, v148, v149
    v_fma_f32 v150, v150, v30, v170
    v_fma_f32 v151, v151, v30, v170
    v_cvt_pk_bf16_f32 v91, v150, v151
    buffer_store_dwordx4 a[248:251], v26, s[28:31], s84 offen sc1
    s_waitcnt lgkmcnt(3)
    v_mfma_f32_32x32x16_bf16 v[208:223], v[188:191], v[84:87], v[208:223]
    ds_read_b128 v[188:191], v25 offset:43008
    v_fma_f32 v152, v152, v30, v170
    v_fma_f32 v153, v153, v30, v170
    v_cvt_pk_bf16_f32 v92, v152, v153
    v_fma_f32 v154, v154, v30, v170
    s_add_u32 s89, s96, 6144
    s_add_u32 m0, s38, 110592
    s_nop 0
    buffer_load_dwordx4 v4, s[28:31], s89 offen offset:0 sc1 lds
    v_mfma_f32_32x32x16_bf16 v[224:239], v[192:195], v[84:87], v[224:239]
    ds_read_b128 v[192:195], v25 offset:44032
    v_fma_f32 v155, v155, v30, v170
    v_cvt_pk_bf16_f32 v93, v154, v155
    v_fma_f32 v156, v156, v30, v170
    v_fma_f32 v157, v157, v30, v170
    v_mfma_f32_32x32x16_bf16 v[240:255], v[196:199], v[84:87], v[240:255]
    ds_read_b128 v[196:199], v25 offset:45056
    v_cvt_pk_bf16_f32 v94, v156, v157
    v_fma_f32 v158, v158, v30, v170
    v_fma_f32 v159, v159, v30, v170
    v_cvt_pk_bf16_f32 v95, v158, v159
    buffer_load_dwordx4 v4, s[28:31], s89 offen offset:1024 sc1 lds
    s_waitcnt lgkmcnt(3)
    v_mfma_f32_32x32x16_bf16 v[208:223], v[176:179], v[88:91], v[208:223]
    buffer_load_dwordx4 v24, s[28:31], s89 offen offset:2048 sc1 lds
    s_waitcnt lgkmcnt(2)
    v_mfma_f32_32x32x16_bf16 v[208:223], v[188:191], v[92:95], v[208:223]
    v_mfma_f32_32x32x16_bf16 v[224:239], v[180:183], v[88:91], v[224:239]
    s_add_u32 s89, s96, 18432
    s_add_u32 m0, s38, 135168
    s_nop 0
    buffer_load_dwordx4 v4, s[28:31], s89 offen offset:0 sc1 lds
    s_waitcnt lgkmcnt(1)
    v_mfma_f32_32x32x16_bf16 v[224:239], v[192:195], v[92:95], v[224:239]
    s_nop 4
    v_cvt_pk_bf16_f32 v216, v216, v217
    v_cvt_pk_bf16_f32 v217, v218, v219
    v_cvt_pk_bf16_f32 v218, v220, v221
    v_cvt_pk_bf16_f32 v219, v222, v223
    ds_write_b128 v173, v[216:219] offset:36864
    v_mfma_f32_32x32x16_bf16 v[240:255], v[184:187], v[88:91], v[240:255]
    buffer_load_dwordx4 v4, s[28:31], s89 offen offset:1024 sc1 lds
    s_waitcnt lgkmcnt(1)
    v_mfma_f32_32x32x16_bf16 v[240:255], v[196:199], v[92:95], v[240:255]
    v_cvt_pk_bf16_f32 v232, v232, v233
    v_cvt_pk_bf16_f32 v233, v234, v235
    v_cvt_pk_bf16_f32 v234, v236, v237
    v_cvt_pk_bf16_f32 v235, v238, v239
    ds_write_b128 v173, v[232:235] offset:37888
    buffer_load_dwordx4 v24, s[28:31], s89 offen offset:2048 sc1 lds
    s_nop 5
    v_cvt_pk_bf16_f32 v248, v248, v249
    v_cvt_pk_bf16_f32 v249, v250, v251
    v_cvt_pk_bf16_f32 v250, v252, v253
    v_cvt_pk_bf16_f32 v251, v254, v255
    ds_write_b128 v173, v[248:251] offset:38912
    s_waitcnt lgkmcnt(0)
    s_barrier
    ds_read_b128 v[220:223], v172 offset:36864
    ds_read_b128 v[236:239], v172 offset:37888
    ds_read_b128 v[252:255], v172 offset:38912
    s_xor_b32 s91, s94, 4194560
    s_add_u32 m0, s7, 0
    s_nop 0
    buffer_load_dwordx4 v20, s[16:19], s91 offen offset:0 lds
    s_waitcnt lgkmcnt(2)
    v_dot2c_f32_bf16 v208, v220, v162
    v_dot2c_f32_bf16 v209, v220, v175
    v_dot2c_f32_bf16 v210, v221, v162
    v_dot2c_f32_bf16 v211, v221, v175
    v_dot2c_f32_bf16 v212, v222, v162
    v_dot2c_f32_bf16 v213, v222, v175
    v_dot2c_f32_bf16 v214, v223, v162
    v_dot2c_f32_bf16 v215, v223, v175
    v_pk_mul_f32 v[216:217], v[208:209], v[208:209]
    v_pk_mul_f32 v[218:219], v[210:211], v[210:211]
    v_pk_mul_f32 v[220:221], v[212:213], v[212:213]
    v_pk_mul_f32 v[222:223], v[214:215], v[214:215]
    v_pk_fma_f32 v[216:217], v[216:217], s[4:5], v[174:175] op_sel_hi:[1,1,0]
    buffer_load_dwordx4 v21, s[16:19], s91 offen offset:1024 lds
    v_pk_fma_f32 v[218:219], v[218:219], s[4:5], v[174:175] op_sel_hi:[1,1,0]
    v_pk_fma_f32 v[220:221], v[220:221], s[4:5], v[174:175] op_sel_hi:[1,1,0]
    v_pk_fma_f32 v[222:223], v[222:223], s[4:5], v[174:175] op_sel_hi:[1,1,0]
    v_pk_mul_f32 v[216:217], v[216:217], v[208:209]
    v_pk_mul_f32 v[218:219], v[218:219], v[210:211]
    v_pk_mul_f32 v[220:221], v[220:221], v[212:213]
    v_pk_mul_f32 v[222:223], v[222:223], v[214:215]
    v_exp_f32 v216, v216
    v_exp_f32 v217, v217
    v_exp_f32 v218, v218
    v_exp_f32 v219, v219
    buffer_load_dwordx4 v22, s[16:19], s91 offen offset:2048 lds
    v_exp_f32 v220, v220
    v_exp_f32 v221, v221
    v_exp_f32 v222, v222
    v_exp_f32 v223, v223
    v_pk_add_f32 v[216:217], v[216:217], v[174:175] op_sel:[0,1] op_sel_hi:[1,1]
    v_pk_add_f32 v[218:219], v[218:219], v[174:175] op_sel:[0,1] op_sel_hi:[1,1]
    v_pk_add_f32 v[220:221], v[220:221], v[174:175] op_sel:[0,1] op_sel_hi:[1,1]
    v_pk_add_f32 v[222:223], v[222:223], v[174:175] op_sel:[0,1] op_sel_hi:[1,1]
    v_rcp_f32 v216, v216
    v_rcp_f32 v217, v217
    buffer_load_dwordx4 v23, s[16:19], s91 offen offset:3072 lds
    v_rcp_f32 v218, v218
    v_rcp_f32 v219, v219
    v_rcp_f32 v220, v220
    v_rcp_f32 v221, v221
    v_rcp_f32 v222, v222
    v_rcp_f32 v223, v223
    v_pk_mul_f32 v[208:209], v[208:209], v[216:217]
    v_pk_mul_f32 v[210:211], v[210:211], v[218:219]
    s_add_u32 s89, s96, 43008
    s_add_u32 m0, s38, 24576
    s_nop 0
    buffer_load_dwordx4 v4, s[28:31], s89 offen offset:0 sc1 lds
    v_pk_mul_f32 v[212:213], v[212:213], v[220:221]
    v_pk_mul_f32 v[214:215], v[214:215], v[222:223]
    s_waitcnt lgkmcnt(1)
    v_dot2c_f32_bf16 v224, v236, v162
    v_dot2c_f32_bf16 v225, v236, v175
    v_dot2c_f32_bf16 v226, v237, v162
    v_dot2c_f32_bf16 v227, v237, v175
    v_dot2c_f32_bf16 v228, v238, v162
    v_dot2c_f32_bf16 v229, v238, v175
    v_dot2c_f32_bf16 v230, v239, v162
    v_dot2c_f32_bf16 v231, v239, v175
    v_pk_mul_f32 v[232:233], v[224:225], v[224:225]
    v_pk_mul_f32 v[234:235], v[226:227], v[226:227]
    v_pk_mul_f32 v[236:237], v[228:229], v[228:229]
    buffer_load_dwordx4 v4, s[28:31], s89 offen offset:1024 sc1 lds
    v_pk_mul_f32 v[238:239], v[230:231], v[230:231]
    v_pk_fma_f32 v[232:233], v[232:233], s[4:5], v[174:175] op_sel_hi:[1,1,0]
    v_pk_fma_f32 v[234:235], v[234:235], s[4:5], v[174:175] op_sel_hi:[1,1,0]
    v_pk_fma_f32 v[236:237], v[236:237], s[4:5], v[174:175] op_sel_hi:[1,1,0]
    v_pk_fma_f32 v[238:239], v[238:239], s[4:5], v[174:175] op_sel_hi:[1,1,0]
    v_pk_mul_f32 v[232:233], v[232:233], v[224:225]
    v_pk_mul_f32 v[234:235], v[234:235], v[226:227]
    v_pk_mul_f32 v[236:237], v[236:237], v[228:229]
    v_pk_mul_f32 v[238:239], v[238:239], v[230:231]
    v_exp_f32 v232, v232
    v_exp_f32 v233, v233
    v_exp_f32 v234, v234
    buffer_load_dwordx4 v24, s[28:31], s89 offen offset:2048 sc1 lds
    v_exp_f32 v235, v235
    v_exp_f32 v236, v236
    v_exp_f32 v237, v237
    v_exp_f32 v238, v238
    v_exp_f32 v239, v239
    v_pk_add_f32 v[232:233], v[232:233], v[174:175] op_sel:[0,1] op_sel_hi:[1,1]
    v_pk_add_f32 v[234:235], v[234:235], v[174:175] op_sel:[0,1] op_sel_hi:[1,1]
    v_pk_add_f32 v[236:237], v[236:237], v[174:175] op_sel:[0,1] op_sel_hi:[1,1]
    v_pk_add_f32 v[238:239], v[238:239], v[174:175] op_sel:[0,1] op_sel_hi:[1,1]
    v_rcp_f32 v232, v232
    s_xor_b32 s91, s94, 512
    s_add_u32 m0, s7, 4096
    s_nop 0
    buffer_load_dwordx4 v20, s[16:19], s91 offen offset:0 lds
    v_rcp_f32 v233, v233
    v_rcp_f32 v234, v234
    v_rcp_f32 v235, v235
    v_rcp_f32 v236, v236
    v_rcp_f32 v237, v237
    v_rcp_f32 v238, v238
    buffer_load_dwordx4 v21, s[16:19], s91 offen offset:1024 lds
    v_rcp_f32 v239, v239
    v_pk_mul_f32 v[224:225], v[224:225], v[232:233]
    v_pk_mul_f32 v[226:227], v[226:227], v[234:235]
    v_pk_mul_f32 v[228:229], v[228:229], v[236:237]
    v_pk_mul_f32 v[230:231], v[230:231], v[238:239]
    s_waitcnt lgkmcnt(0)
    v_dot2c_f32_bf16 v240, v252, v162
    v_dot2c_f32_bf16 v241, v252, v175
    v_dot2c_f32_bf16 v242, v253, v162
    v_dot2c_f32_bf16 v243, v253, v175
    v_dot2c_f32_bf16 v244, v254, v162
    v_dot2c_f32_bf16 v245, v254, v175
    v_dot2c_f32_bf16 v246, v255, v162
    v_dot2c_f32_bf16 v247, v255, v175
    v_pk_mul_f32 v[248:249], v[240:241], v[240:241]
    buffer_load_dwordx4 v22, s[16:19], s91 offen offset:2048 lds
    v_pk_mul_f32 v[250:251], v[242:243], v[242:243]
    v_pk_mul_f32 v[252:253], v[244:245], v[244:245]
    v_pk_mul_f32 v[254:255], v[246:247], v[246:247]
    v_pk_fma_f32 v[248:249], v[248:249], s[4:5], v[174:175] op_sel_hi:[1,1,0]
    v_pk_fma_f32 v[250:251], v[250:251], s[4:5], v[174:175] op_sel_hi:[1,1,0]
    v_pk_fma_f32 v[252:253], v[252:253], s[4:5], v[174:175] op_sel_hi:[1,1,0]
    v_pk_fma_f32 v[254:255], v[254:255], s[4:5], v[174:175] op_sel_hi:[1,1,0]
    v_pk_mul_f32 v[248:249], v[248:249], v[240:241]
    v_pk_mul_f32 v[250:251], v[250:251], v[242:243]
    v_pk_mul_f32 v[252:253], v[252:253], v[244:245]
    v_pk_mul_f32 v[254:255], v[254:255], v[246:247]
    v_exp_f32 v248, v248
    v_exp_f32 v249, v249
    buffer_load_dwordx4 v23, s[16:19], s91 offen offset:3072 lds
    v_exp_f32 v250, v250
    v_exp_f32 v251, v251
    v_exp_f32 v252, v252
    v_exp_f32 v253, v253
    v_exp_f32 v254, v254
    v_exp_f32 v255, v255
    v_pk_add_f32 v[248:249], v[248:249], v[174:175] op_sel:[0,1] op_sel_hi:[1,1]
    v_pk_add_f32 v[250:251], v[250:251], v[174:175] op_sel:[0,1] op_sel_hi:[1,1]
    v_pk_add_f32 v[252:253], v[252:253], v[174:175] op_sel:[0,1] op_sel_hi:[1,1]
    v_pk_add_f32 v[254:255], v[254:255], v[174:175] op_sel:[0,1] op_sel_hi:[1,1]
    v_rcp_f32 v248, v248
    v_rcp_f32 v249, v249
    v_rcp_f32 v250, v250
    v_rcp_f32 v251, v251
    v_rcp_f32 v252, v252
    v_rcp_f32 v253, v253
    v_rcp_f32 v254, v254
    v_rcp_f32 v255, v255
    v_pk_mul_f32 v[240:241], v[240:241], v[248:249]
    v_pk_mul_f32 v[242:243], v[242:243], v[250:251]
    v_pk_mul_f32 v[244:245], v[244:245], v[252:253]
    v_pk_mul_f32 v[246:247], v[246:247], v[254:255]
    v_pk_add_f32 v[164:165], v[208:209], v[210:211]
    v_pk_mul_f32 v[166:167], v[208:209], v[208:209]
    v_pk_fma_f32 v[166:167], v[210:211], v[210:211], v[166:167]
    v_pk_add_f32 v[164:165], v[164:165], v[212:213]
    v_pk_fma_f32 v[166:167], v[212:213], v[212:213], v[166:167]
    v_pk_add_f32 v[164:165], v[164:165], v[214:215]
    v_pk_fma_f32 v[166:167], v[214:215], v[214:215], v[166:167]
    v_pk_add_f32 v[164:165], v[164:165], v[224:225]
    v_pk_fma_f32 v[166:167], v[224:225], v[224:225], v[166:167]
    v_pk_add_f32 v[164:165], v[164:165], v[226:227]
    v_pk_fma_f32 v[166:167], v[226:227], v[226:227], v[166:167]
    v_pk_add_f32 v[164:165], v[164:165], v[228:229]
    v_pk_fma_f32 v[166:167], v[228:229], v[228:229], v[166:167]
    v_pk_add_f32 v[164:165], v[164:165], v[230:231]
    v_pk_fma_f32 v[166:167], v[230:231], v[230:231], v[166:167]
    v_pk_add_f32 v[164:165], v[164:165], v[240:241]
    v_pk_fma_f32 v[166:167], v[240:241], v[240:241], v[166:167]
    v_pk_add_f32 v[164:165], v[164:165], v[242:243]
    v_pk_fma_f32 v[166:167], v[242:243], v[242:243], v[166:167]
    v_pk_add_f32 v[164:165], v[164:165], v[244:245]
    v_pk_fma_f32 v[166:167], v[244:245], v[244:245], v[166:167]
    v_pk_add_f32 v[164:165], v[164:165], v[246:247]
    v_pk_fma_f32 v[166:167], v[246:247], v[246:247], v[166:167]
    v_add_f32 v164, v164, v165
    v_add_f32 v166, v166, v167
    s_nop 1
    v_permlane32_swap_b32 v164, v166
    v_add_f32 v164, v164, v166
    s_waitcnt vmcnt(17)
    buffer_store_dword v164, v12, s[28:31], s82 offen sc1
    s_waitcnt vmcnt(8)
    ds_read_b128 a[68:71], v200 offset:0
    ds_read_b128 a[76:79], v201 offset:0
    ds_read_b128 a[84:87], v202 offset:0
    ds_read_b128 a[92:95], v203 offset:0
    s_add_u32 m0, s38, 36864
    s_nop 0
    buffer_load_dwordx4 v27, s[20:23], s36 offen lds
    s_waitcnt lgkmcnt(0)
    s_xor_b32 s91, s94, 4194304
    s_add_u32 m0, s7, 0
    s_nop 0
    buffer_load_dwordx4 v20, s[16:19], s91 offen offset:0 lds
    buffer_load_dwordx4 v21, s[16:19], s91 offen offset:1024 lds
    buffer_load_dwordx4 v22, s[16:19], s91 offen offset:2048 lds
    buffer_load_dwordx4 v23, s[16:19], s91 offen offset:3072 lds
    s_barrier
    ds_read_b128 v[176:179], v29 offset:0
    ds_read_b128 v[180:183], v29 offset:1024
    ds_read_b128 v[184:187], v29 offset:2048
    ds_read_b128 v[188:191], v29 offset:6144
    ds_read_b128 v[192:195], v29 offset:7168
    ds_read_b128 v[196:199], v29 offset:8192
    s_waitcnt lgkmcnt(3)
    v_mfma_f32_32x32x16_bf16 v[96:111], v[176:179], v[32:35], 0
    ds_read_b128 v[176:179], v29 offset:12288
    s_lshl_b32 s66, s54, 12
    s_and_b32 s70, s58, 1
    s_lshl_b32 s70, s70, 1
    v_mfma_f32_32x32x16_bf16 v[112:127], v[180:183], v[32:35], 0
    ds_read_b128 v[180:183], v29 offset:13312
    v_bfe_u32 v6, v1, 2, 2
    v_xor_b32 v7, v6, v3
    v_xor_b32 v7, s70, v7
    v_mfma_f32_32x32x16_bf16 v[128:143], v[184:187], v[32:35], 0
    ds_read_b128 v[184:187], v29 offset:14336
    v_lshlrev_b32 v7, 4, v7
    v_and_b32 v8, 15, v1
    v_lshl_add_u32 v7, v8, 6, v7
    s_waitcnt lgkmcnt(3)
    v_mfma_f32_32x32x16_bf16 v[96:111], v[188:191], v[36:39], v[96:111]
    ds_read_b128 v[188:191], v29 offset:18432
    v_bfe_u32 v6, v1, 4, 1
    v_lshl_add_u32 v7, v6, 11, v7
    v_add_u32 v160, s66, v7
    v_mfma_f32_32x32x16_bf16 v[112:127], v[192:195], v[36:39], v[112:127]
    ds_read_b128 v[192:195], v29 offset:19456
    v_xor_b32 v16, 32, v160
    v_lshrrev_b32 v6, 4, v2
    v_mul_u32_u24 v6, 3072, v6
    v_mfma_f32_32x32x16_bf16 v[128:143], v[196:199], v[36:39], v[128:143]
    ds_read_b128 v[196:199], v29 offset:20480
    v_lshl_add_u32 v6, v8, 4, v6
    v_lshl_add_u32 v6, v3, 8, v6
    s_mul_i32 s70, s55, 6144
    s_waitcnt lgkmcnt(3)
    v_mfma_f32_32x32x16_bf16 v[96:111], v[176:179], v[40:43], v[96:111]
    ds_read_b128 v[176:179], v29 offset:24576
    s_mul_i32 s71, s56, 37376
    s_add_u32 s70, s70, s71
    v_add_u32 v173, s70, v6
    v_mfma_f32_32x32x16_bf16 v[112:127], v[180:183], v[40:43], v[112:127]
    ds_read_b128 v[180:183], v29 offset:25600
    v_xor_b32 v14, 512, v173
    s_xor_b32 s70, s54, 0
    s_mul_i32 s70, s70, 3072
    v_mfma_f32_32x32x16_bf16 v[128:143], v[184:187], v[40:43], v[128:143]
    ds_read_b128 v[184:187], v29 offset:26624
    s_add_u32 s70, s70, 151552
    v_add_u32 v164, s70, v4
    s_xor_b32 s70, s54, 1
    s_waitcnt lgkmcnt(3)
    v_mfma_f32_32x32x16_bf16 v[96:111], v[188:191], v[44:47], v[96:111]
    ds_read_b128 v[188:191], v29 offset:30720
    s_mul_i32 s70, s70, 3072
    s_add_u32 s70, s70, 151552
    v_add_u32 v165, s70, v4
    v_mfma_f32_32x32x16_bf16 v[112:127], v[192:195], v[44:47], v[112:127]
    ds_read_b128 v[192:195], v29 offset:31744
    s_xor_b32 s70, s54, 2
    s_mul_i32 s70, s70, 3072
    s_add_u32 s70, s70, 151552
    v_mfma_f32_32x32x16_bf16 v[128:143], v[196:199], v[44:47], v[128:143]
    ds_read_b128 v[196:199], v29 offset:32768
    v_add_u32 v166, s70, v4
    s_xor_b32 s70, s54, 3
    s_mul_i32 s70, s70, 3072
    s_waitcnt lgkmcnt(3)
    v_mfma_f32_32x32x16_bf16 v[96:111], v[176:179], v[48:51], v[96:111]
    ds_read_b128 v[176:179], v29 offset:36864
    s_add_u32 s70, s70, 151552
    v_add_u32 v167, s70, v4
    v_mov_b32 v162, 0x3f80
    v_mfma_f32_32x32x16_bf16 v[112:127], v[180:183], v[48:51], v[112:127]
    ds_read_b128 v[180:183], v29 offset:37888
    v_mov_b32 v163, 1.0
    v_mfma_f32_32x32x16_bf16 v[128:143], v[184:187], v[48:51], v[128:143]
    ds_read_b128 v[184:187], v29 offset:38912
    s_waitcnt lgkmcnt(3)
    v_mfma_f32_32x32x16_bf16 v[96:111], v[188:191], v[52:55], v[96:111]
    ds_read_b128 v[188:191], v29 offset:43008
    v_mfma_f32_32x32x16_bf16 v[112:127], v[192:195], v[52:55], v[112:127]
    ds_read_b128 v[192:195], v29 offset:44032
    v_mfma_f32_32x32x16_bf16 v[128:143], v[196:199], v[52:55], v[128:143]
    ds_read_b128 v[196:199], v29 offset:45056
    s_barrier
    s_waitcnt lgkmcnt(3)
    v_mfma_f32_32x32x16_bf16 v[96:111], v[176:179], v[56:59], v[96:111]
    ds_read_b128 v[176:179], v29 offset:49152
    s_xor_b32 s91, s95, 0
    s_add_u32 m0, s7, 32768
    s_nop 0
    buffer_load_dwordx4 v20, s[16:19], s91 offen offset:0 lds
    v_mfma_f32_32x32x16_bf16 v[112:127], v[180:183], v[56:59], v[112:127]
    ds_read_b128 v[180:183], v29 offset:50176
    buffer_load_dwordx4 v21, s[16:19], s91 offen offset:1024 lds
    v_mfma_f32_32x32x16_bf16 v[128:143], v[184:187], v[56:59], v[128:143]
    ds_read_b128 v[184:187], v29 offset:51200
    buffer_load_dwordx4 v22, s[16:19], s91 offen offset:2048 lds
    s_waitcnt lgkmcnt(3)
    v_mfma_f32_32x32x16_bf16 v[96:111], v[188:191], v[60:63], v[96:111]
    ds_read_b128 v[188:191], v29 offset:55296
    buffer_load_dwordx4 v23, s[16:19], s91 offen offset:3072 lds
    v_mfma_f32_32x32x16_bf16 v[112:127], v[192:195], v[60:63], v[112:127]
    ds_read_b128 v[192:195], v29 offset:56320
    v_mfma_f32_32x32x16_bf16 v[128:143], v[196:199], v[60:63], v[128:143]
    ds_read_b128 v[196:199], v29 offset:57344
    buffer_load_dword v144, v12, s[28:31], s81 offen offset:0 sc1
    buffer_load_dword v145, v12, s[28:31], s81 offen offset:256 sc1
    buffer_load_dword v146, v12, s[28:31], s81 offen offset:512 sc1
    buffer_load_dword v147, v12, s[28:31], s81 offen offset:768 sc1
    s_waitcnt lgkmcnt(3)
    v_mfma_f32_32x32x16_bf16 v[96:111], v[176:179], v[64:67], v[96:111]
    ds_read_b128 v[176:179], v28 offset:0
    buffer_load_dword v148, v12, s[28:31], s81 offen offset:1024 sc1
    buffer_load_dword v149, v12, s[28:31], s81 offen offset:1280 sc1
    buffer_load_dword v150, v12, s[28:31], s81 offen offset:1536 sc1
    buffer_load_dword v151, v12, s[28:31], s81 offen offset:1792 sc1
    v_mfma_f32_32x32x16_bf16 v[112:127], v[180:183], v[64:67], v[112:127]
    ds_read_b128 v[180:183], v28 offset:1024
    buffer_load_dword v152, v12, s[28:31], s81 offen offset:2048 sc1
    buffer_load_dword v153, v12, s[28:31], s81 offen offset:2304 sc1
    buffer_load_dword v154, v12, s[28:31], s81 offen offset:2560 sc1
    buffer_load_dword v155, v12, s[28:31], s81 offen offset:2816 sc1
    v_mfma_f32_32x32x16_bf16 v[128:143], v[184:187], v[64:67], v[128:143]
    ds_read_b128 v[184:187], v28 offset:2048
    s_waitcnt lgkmcnt(3)
    v_mfma_f32_32x32x16_bf16 v[96:111], v[188:191], v[68:71], v[96:111]
    ds_read_b128 v[188:191], v28 offset:6144
    buffer_load_dword v156, v12, s[28:31], s81 offen offset:3072 sc1
    buffer_load_dword v157, v12, s[28:31], s81 offen offset:3328 sc1
    buffer_load_dword v158, v12, s[28:31], s81 offen offset:3584 sc1
    buffer_load_dword v159, v12, s[28:31], s81 offen offset:3840 sc1
    v_mfma_f32_32x32x16_bf16 v[112:127], v[192:195], v[68:71], v[112:127]
    ds_read_b128 v[192:195], v28 offset:7168
    v_lshlrev_b32 v9, 6, v3
    v_xor_b32 v9, s40, v9
    v_and_or_b32 v9, v5, 56, v9
    v_bfe_u32 v27, v1, 2, 2
    v_lshl_add_u32 v9, v27, 7, v9
    v_add_u32 v9, s38, v9
    s_waitcnt vmcnt(24)
    ds_read_b64_tr_b16 v[252:253], v9 offset:36864
    ds_read_b64_tr_b16 v[254:255], v9 offset:37376
    v_lshlrev_b32 v27, 4, v2
    v_lshl_add_u32 v27, v3, 10, v27
    v_mfma_f32_32x32x16_bf16 v[128:143], v[196:199], v[68:71], v[128:143]
    ds_read_b128 v[196:199], v28 offset:8192
    s_barrier
    s_xor_b32 s91, s95, 4194560
    s_add_u32 m0, s7, 36864
    s_nop 0
    buffer_load_dwordx4 v20, s[16:19], s91 offen offset:0 lds
    s_waitcnt lgkmcnt(5)
    v_mfma_f32_32x32x16_bf16 v[96:111], v[176:179], v[72:75], v[96:111]
    ds_read_b128 v[176:179], v28 offset:12288
    v_mfma_f32_32x32x16_bf16 v[112:127], v[180:183], v[72:75], v[112:127]
    ds_read_b128 v[180:183], v28 offset:13312
    buffer_load_dwordx4 v21, s[16:19], s91 offen offset:1024 lds
    v_mfma_f32_32x32x16_bf16 v[128:143], v[184:187], v[72:75], v[128:143]
    ds_read_b128 v[184:187], v28 offset:14336
    buffer_load_dwordx4 v22, s[16:19], s91 offen offset:2048 lds
    s_waitcnt lgkmcnt(3)
    v_mfma_f32_32x32x16_bf16 v[96:111], v[188:191], v[76:79], v[96:111]
    ds_read_b128 v[188:191], v28 offset:18432
    buffer_load_dwordx4 v23, s[16:19], s91 offen offset:3072 lds
    v_mfma_f32_32x32x16_bf16 v[112:127], v[192:195], v[76:79], v[112:127]
    ds_read_b128 v[192:195], v28 offset:19456
    s_xor_b32 s91, s95, 256
    s_add_u32 m0, s7, 65536
    s_nop 0
    buffer_load_dwordx4 v20, s[16:19], s91 offen offset:0 lds
    v_mfma_f32_32x32x16_bf16 v[128:143], v[196:199], v[76:79], v[128:143]
    ds_read_b128 v[196:199], v28 offset:20480
    s_waitcnt lgkmcnt(3)
    v_mfma_f32_32x32x16_bf16 v[96:111], v[176:179], v[80:83], v[96:111]
    ds_read_b128 v[176:179], v28 offset:24576
    buffer_load_dwordx4 v21, s[16:19], s91 offen offset:1024 lds
    v_mfma_f32_32x32x16_bf16 v[112:127], v[180:183], v[80:83], v[112:127]
    ds_read_b128 v[180:183], v28 offset:25600
    buffer_load_dwordx4 v22, s[16:19], s91 offen offset:2048 lds
    v_mfma_f32_32x32x16_bf16 v[128:143], v[184:187], v[80:83], v[128:143]
    ds_read_b128 v[184:187], v28 offset:26624
    buffer_load_dwordx4 v23, s[16:19], s91 offen offset:3072 lds
    s_waitcnt lgkmcnt(3)
    v_mfma_f32_32x32x16_bf16 v[96:111], v[188:191], v[84:87], v[96:111]
    ds_read_b128 v[188:191], v28 offset:30720
    v_mfma_f32_32x32x16_bf16 v[112:127], v[192:195], v[84:87], v[112:127]
    ds_read_b128 v[192:195], v28 offset:31744
    ds_read_b128 a[32:35], v200 offset:4096
    ds_read_b128 a[40:43], v201 offset:4096
    ds_read_b128 a[48:51], v202 offset:4096
    ds_read_b128 a[56:59], v203 offset:4096
    v_mfma_f32_32x32x16_bf16 v[128:143], v[196:199], v[84:87], v[128:143]
    ds_read_b128 v[196:199], v28 offset:32768
    s_barrier
    s_waitcnt lgkmcnt(7)
    v_mfma_f32_32x32x16_bf16 v[96:111], v[176:179], v[88:91], v[96:111]
    v_mfma_f32_32x32x16_bf16 v[112:127], v[180:183], v[88:91], v[112:127]
    buffer_store_dwordx4 v[252:255], v27, s[28:31], s37 offen sc1
    v_mfma_f32_32x32x16_bf16 v[128:143], v[184:187], v[88:91], v[128:143]
    s_waitcnt lgkmcnt(6)
    v_mfma_f32_32x32x16_bf16 v[96:111], v[188:191], v[92:95], v[96:111]
    s_waitcnt lgkmcnt(5)
    v_mfma_f32_32x32x16_bf16 v[112:127], v[192:195], v[92:95], v[112:127]
    s_waitcnt lgkmcnt(0)
    v_mfma_f32_32x32x16_bf16 v[128:143], v[196:199], v[92:95], v[128:143]
    s_waitcnt vmcnt(9)
L_ag_10:
    v_max3_u32 v6, v144, v145, v146
    v_max3_u32 v6, v6, v147, v148
    v_max3_u32 v6, v6, v149, v150
    v_max3_u32 v6, v6, v151, v152
    v_max3_u32 v6, v6, v153, v154
    v_max3_u32 v6, v6, v155, v156
    v_max3_u32 v6, v6, v157, v158
    v_max_u32 v6, v6, v159
    v_cmp_eq_u32 vcc, -1, v6
    s_cbranch_vccnz L_rt_11
L_rc_12:
    v_pk_add_f32 v[144:145], v[144:145], v[152:153]
    v_pk_add_f32 v[146:147], v[146:147], v[154:155]
    v_pk_add_f32 v[148:149], v[148:149], v[156:157]
    v_pk_add_f32 v[150:151], v[150:151], v[158:159]
    v_pk_add_f32 v[144:145], v[144:145], v[148:149]
    v_pk_add_f32 v[146:147], v[146:147], v[150:151]
    v_pk_add_f32 v[144:145], v[144:145], v[146:147]
    v_add_f32 v144, v144, v145
    v_mov_b32 v145, v144
    s_nop 1
    v_permlane32_swap_b32 v144, v145
    v_mul_f32 v146, 0x3abe82fa, v144
    v_mul_f32 v30, 0x3abe82fa, v145
    v_fma_f32 v30, -v146, v146, v30
    v_max_f32 v30, 0, v30
    v_add_f32 v30, 0x3727c5ac, v30
    v_rsq_f32 v30, v30
    s_nop 0
    v_mul_f32 v170, v146, v30
    v_sub_f32 v170, 0, v170
    v_pk_fma_f32 v[208:209], v[208:209], v[30:31], v[170:171] op_sel_hi:[1,0,0]
    v_pk_fma_f32 v[210:211], v[210:211], v[30:31], v[170:171] op_sel_hi:[1,0,0]
    v_pk_fma_f32 v[212:213], v[212:213], v[30:31], v[170:171] op_sel_hi:[1,0,0]
    v_pk_fma_f32 v[214:215], v[214:215], v[30:31], v[170:171] op_sel_hi:[1,0,0]
    v_cvt_pk_bf16_f32 v216, v208, v209
    v_cvt_pk_bf16_f32 v217, v210, v211
    v_cvt_pk_bf16_f32 v218, v212, v213
    v_cvt_pk_bf16_f32 v219, v214, v215
    buffer_store_dwordx4 v[216:219], v11, s[28:31], s78 offen sc1
    v_pk_fma_f32 v[224:225], v[224:225], v[30:31], v[170:171] op_sel_hi:[1,0,0]
    v_pk_fma_f32 v[226:227], v[226:227], v[30:31], v[170:171] op_sel_hi:[1,0,0]
    v_pk_fma_f32 v[228:229], v[228:229], v[30:31], v[170:171] op_sel_hi:[1,0,0]
    v_pk_fma_f32 v[230:231], v[230:231], v[30:31], v[170:171] op_sel_hi:[1,0,0]
    v_cvt_pk_bf16_f32 v232, v224, v225
    v_cvt_pk_bf16_f32 v233, v226, v227
    v_cvt_pk_bf16_f32 v234, v228, v229
    v_cvt_pk_bf16_f32 v235, v230, v231
    buffer_store_dwordx4 v[232:235], v11, s[28:31], s79 offen sc1
    v_pk_fma_f32 v[240:241], v[240:241], v[30:31], v[170:171] op_sel_hi:[1,0,0]
    v_pk_fma_f32 v[242:243], v[242:243], v[30:31], v[170:171] op_sel_hi:[1,0,0]
    v_pk_fma_f32 v[244:245], v[244:245], v[30:31], v[170:171] op_sel_hi:[1,0,0]
    v_pk_fma_f32 v[246:247], v[246:247], v[30:31], v[170:171] op_sel_hi:[1,0,0]
    v_cvt_pk_bf16_f32 v248, v240, v241
    v_cvt_pk_bf16_f32 v249, v242, v243
    v_cvt_pk_bf16_f32 v250, v244, v245
    v_cvt_pk_bf16_f32 v251, v246, v247
    buffer_store_dwordx4 v[248:251], v10, s[28:31], s80 offen sc1
    v_cvt_pk_bf16_f32 v96, v96, v97
    v_cvt_pk_bf16_f32 v97, v98, v99
    v_cvt_pk_bf16_f32 v98, v100, v101
    v_cvt_pk_bf16_f32 v99, v102, v103
    ds_write_b128 v173, v[96:99] offset:0
    v_cvt_pk_bf16_f32 v104, v104, v105
    v_cvt_pk_bf16_f32 v105, v106, v107
    v_cvt_pk_bf16_f32 v106, v108, v109
    v_cvt_pk_bf16_f32 v107, v110, v111
    ds_write_b128 v14, v[104:107] offset:0
    v_cvt_pk_bf16_f32 v112, v112, v113
    v_cvt_pk_bf16_f32 v113, v114, v115
    v_cvt_pk_bf16_f32 v114, v116, v117
    v_cvt_pk_bf16_f32 v115, v118, v119
    ds_write_b128 v173, v[112:115] offset:1024
    v_cvt_pk_bf16_f32 v120, v120, v121
    v_cvt_pk_bf16_f32 v121, v122, v123
    v_cvt_pk_bf16_f32 v122, v124, v125
    v_cvt_pk_bf16_f32 v123, v126, v127
    ds_write_b128 v14, v[120:123] offset:1024
    v_cvt_pk_bf16_f32 v128, v128, v129
    v_cvt_pk_bf16_f32 v129, v130, v131
    v_cvt_pk_bf16_f32 v130, v132, v133
    v_cvt_pk_bf16_f32 v131, v134, v135
    ds_write_b128 v173, v[128:131] offset:2048
    v_cvt_pk_bf16_f32 v136, v136, v137
    v_cvt_pk_bf16_f32 v137, v138, v139
    v_cvt_pk_bf16_f32 v138, v140, v141
    v_cvt_pk_bf16_f32 v139, v142, v143
    ds_write_b128 v14, v[136:139] offset:2048
    s_waitcnt vmcnt(8)
    ds_read_b128 a[196:199], v200 offset:36864
    ds_read_b128 a[204:207], v201 offset:36864
    ds_read_b128 a[212:215], v202 offset:36864
    ds_read_b128 a[220:223], v203 offset:36864
    s_waitcnt lgkmcnt(0)
    s_barrier
    ds_read_b128 v[104:107], v172 offset:0
    ds_read_b128 v[108:111], v172 offset:36864
    ds_read_b128 v[120:123], v172 offset:1024
    ds_read_b128 v[124:127], v172 offset:37888
    ds_read_b128 v[136:139], v172 offset:2048
    ds_read_b128 v[140:143], v172 offset:38912
    s_xor_b32 s91, s95, 4194304
    s_add_u32 m0, s7, 69632
    s_nop 0
    buffer_load_dwordx4 v20, s[16:19], s91 offen offset:0 lds
    buffer_load_dwordx4 v21, s[16:19], s91 offen offset:1024 lds
    buffer_load_dwordx4 v22, s[16:19], s91 offen offset:2048 lds
    buffer_load_dwordx4 v23, s[16:19], s91 offen offset:3072 lds
    s_xor_b32 s91, s94, 768
    s_add_u32 m0, s7, 4096
    s_nop 0
    buffer_load_dwordx4 v20, s[16:19], s91 offen offset:0 lds
    buffer_load_dwordx4 v21, s[16:19], s91 offen offset:1024 lds
    buffer_load_dwordx4 v22, s[16:19], s91 offen offset:2048 lds
    buffer_load_dwordx4 v23, s[16:19], s91 offen offset:3072 lds
    s_waitcnt vmcnt(8)
    s_lshl_b32 s65, s58, 5
    s_add_u32 s65, s65, s57
    s_lshr_b32 s6, s65, 3
    s_mul_i32 s6, s6, 0
    s_lshl_b32 s65, s65, 4
    s_add_u32 s65, s65, s6
    s_lshl_b32 s6, s54, 2
    s_add_u32 s65, s65, s6
    s_add_u32 s65, s65, 14680064
    s_barrier
    s_cmp_eq_u32 s54, 0
    s_cselect_b32 s65, s65, 0x40000000
    s_mov_b64 exec, 15
    buffer_store_dword v31, v12, s[28:31], s65 offen sc1
    s_mov_b64 exec, -1
    s_xor_b32 s91, s94, 4194816
    s_add_u32 m0, s7, 36864
    s_nop 0
    buffer_load_dwordx4 v20, s[16:19], s91 offen offset:0 lds
    buffer_load_dwordx4 v21, s[16:19], s91 offen offset:1024 lds
    buffer_load_dwordx4 v22, s[16:19], s91 offen offset:2048 lds
    buffer_load_dwordx4 v23, s[16:19], s91 offen offset:3072 lds
    ds_read_b128 a[132:135], v204 offset:0
    ds_read_b128 a[140:143], v205 offset:0
    ds_read_b128 a[148:151], v206 offset:0
    ds_read_b128 a[156:159], v207 offset:0
    ds_read_b128 a[128:131], v200 offset:32768
    ds_read_b128 a[136:139], v201 offset:32768
    ds_read_b128 a[144:147], v202 offset:32768
    ds_read_b128 a[152:155], v203 offset:32768
    ds_read_b128 a[64:67], v200 offset:0
    ds_read_b128 a[72:75], v201 offset:0
    ds_read_b128 a[80:83], v202 offset:0
    ds_read_b128 a[88:91], v203 offset:0
    s_waitcnt lgkmcnt(8)
    s_xor_b32 s91, s94, 4195072
    s_add_u32 m0, s7, 65536
    s_nop 0
    buffer_load_dwordx4 v20, s[16:19], s91 offen offset:0 lds
    buffer_load_dwordx4 v21, s[16:19], s91 offen offset:1024 lds
    buffer_load_dwordx4 v22, s[16:19], s91 offen offset:2048 lds
    buffer_load_dwordx4 v23, s[16:19], s91 offen offset:3072 lds
    s_waitcnt lgkmcnt(0)
    s_mov_b32 s70, s38
    v_and_b32 v6, 15, v2
    v_mul_u32_u24 v6, 144, v6
    v_lshrrev_b32 v7, 4, v2
    v_mul_u32_u24 v7, 36864, v7
    v_add_u32 v8, v6, v7
    v_lshl_add_u32 v7, v3, 4, v8
    v_add_u32 v7, s70, v7
    s_mul_i32 s71, s56, 7
    s_xor_b32 s71, s71, s58
    s_lshr_b32 s70, s58, 2
    s_cmp_lg_u32 s70, s56
    s_cbranch_scc1 L_st_end_13
    s_cmp_lg_u32 s71, 0
    s_cbranch_scc1 L_st_15
    ds_write_b128 v7, v[32:35] offset:0
    ds_write_b128 v7, v[36:39] offset:32
    ds_write_b128 v7, v[40:43] offset:64
    ds_write_b128 v7, v[44:47] offset:96
    s_mov_b32 exec_hi, 0
    ds_write_b32 v7, v48 offset:128
    s_mov_b32 exec_hi, -1
    s_waitcnt lgkmcnt(0)
    s_branch L_st_end_13
L_st_15:
    s_cmp_lg_u32 s71, 1
    s_cbranch_scc1 L_st_16
    ds_write_b128 v7, v[48:51] offset:0
    ds_write_b128 v7, v[52:55] offset:32
    ds_write_b128 v7, v[56:59] offset:64
    ds_write_b128 v7, v[60:63] offset:96
    s_mov_b32 exec_hi, 0
    ds_write_b32 v7, v64 offset:128
    s_mov_b32 exec_hi, -1
    s_waitcnt lgkmcnt(0)
    s_branch L_st_end_13
L_st_16:
    s_cmp_lg_u32 s71, 2
    s_cbranch_scc1 L_st_17
    ds_write_b128 v7, v[64:67] offset:0
    ds_write_b128 v7, v[68:71] offset:32
    ds_write_b128 v7, v[72:75] offset:64
    ds_write_b128 v7, v[76:79] offset:96
    s_mov_b32 exec_hi, 0
    ds_write_b32 v7, v80 offset:128
    s_mov_b32 exec_hi, -1
    s_waitcnt lgkmcnt(0)
    s_branch L_st_end_13
L_st_17:
    ds_write_b128 v7, v[80:83] offset:0
    ds_write_b128 v7, v[84:87] offset:32
    ds_write_b128 v7, v[88:91] offset:64
    ds_write_b128 v7, v[92:95] offset:96
    s_mov_b32 exec_hi, 0
    ds_write_b32 v7, v32 offset:128
    s_mov_b32 exec_hi, -1
    s_waitcnt lgkmcnt(0)
L_st_end_13:
    s_lshr_b32 s70, s58, 2
    s_mul_i32 s73, s70, 3184
    s_cmp_eq_u32 s70, 0
    s_cselect_b32 s71, 16, -16
    s_cselect_b32 s42, 0x05040c0c, 0
    s_cselect_b32 s43, 0, 0x01000c0c
    s_or_b32 s42, s42, s43
    s_add_u32 s43, s42, 0x02020000
    s_mul_i32 s72, s55, 6144
    s_add_u32 s73, s73, s72
    s_lshl_b32 s72, s56, 2
    v_add_u32 v6, s72, v3
    v_mul_lo_u32 v6, v6, s71
    v_add3_u32 v6, v6, v8, s73
    s_lshl_b32 s72, s71, 1
    v_add_u32 v7, s72, v6
    s_barrier
    ds_read_b128 v[176:179], v6
    ds_read_b32 v180, v6 offset:16
    ds_read_b128 v[184:187], v7
    ds_read_b32 v188, v7 offset:16
    s_xor_b32 s91, s95, 512
    s_add_u32 m0, s7, 32768
    s_nop 0
    buffer_load_dwordx4 v20, s[16:19], s91 offen offset:0 lds
    v_sqrt_f32 v169, v169
    s_waitcnt lgkmcnt(2)
    v_perm_b32 v144, v176, v180, s42
    v_perm_b32 v145, v176, v179, s43
    v_perm_b32 v146, v177, v179, s42
    v_perm_b32 v147, v177, v178, s43
    v_perm_b32 v148, v178, v178, s42
    buffer_load_dwordx4 v21, s[16:19], s91 offen offset:1024 lds
    v_perm_b32 v149, v178, v177, s43
    v_perm_b32 v150, v179, v177, s42
    v_perm_b32 v151, v179, v176, s43
    s_waitcnt lgkmcnt(0)
    v_perm_b32 v152, v184, v188, s42
    v_perm_b32 v153, v184, v187, s43
    v_perm_b32 v154, v185, v187, s42
    v_perm_b32 v155, v185, v186, s43
    v_perm_b32 v156, v186, v186, s42
    v_perm_b32 v157, v186, v185, s43
    buffer_load_dwordx4 v22, s[16:19], s91 offen offset:2048 lds
    v_perm_b32 v158, v187, v185, s42
    v_perm_b32 v159, v187, v184, s43
    v_fma_f32 v144, v144, v169, v168
    v_fma_f32 v145, v145, v169, v168
    v_fma_f32 v146, v146, v169, v168
    v_fma_f32 v147, v147, v169, v168
    v_fma_f32 v148, v148, v169, v168
    v_fma_f32 v149, v149, v169, v168
    v_fma_f32 v150, v150, v169, v168
    buffer_load_dwordx4 v23, s[16:19], s91 offen offset:3072 lds
    v_fma_f32 v151, v151, v169, v168
    v_fma_f32 v152, v152, v169, v168
    v_fma_f32 v153, v153, v169, v168
    v_fma_f32 v154, v154, v169, v168
    v_fma_f32 v155, v155, v169, v168
    v_fma_f32 v156, v156, v169, v168
    v_fma_f32 v157, v157, v169, v168
    v_fma_f32 v158, v158, v169, v168
    v_fma_f32 v159, v159, v169, v168
    s_waitcnt vmcnt(13)
    ds_read_b128 a[36:39], v200 offset:4096
    ds_read_b128 a[44:47], v201 offset:4096
    ds_read_b128 a[52:55], v202 offset:4096
    ds_read_b128 a[60:63], v203 offset:4096
    s_barrier
    s_xor_b32 s91, s95, 4194816
    s_add_u32 m0, s7, 0
    s_nop 0
    buffer_load_dwordx4 v20, s[16:19], s91 offen offset:0 lds
    v_lshlrev_b32 v96, 16, v104
    v_and_b32 v97, s39, v104
    v_lshlrev_b32 v98, 16, v105
    buffer_load_dwordx4 v21, s[16:19], s91 offen offset:1024 lds
    v_and_b32 v99, s39, v105
    v_lshlrev_b32 v100, 16, v106
    v_and_b32 v101, s39, v106
    v_lshlrev_b32 v102, 16, v107
    v_and_b32 v103, s39, v107
    buffer_load_dwordx4 v22, s[16:19], s91 offen offset:2048 lds
    v_dot2c_f32_bf16 v96, v108, v162
    v_dot2c_f32_bf16 v97, v108, v163
    v_dot2c_f32_bf16 v98, v109, v162
    v_dot2c_f32_bf16 v99, v109, v163
    v_dot2c_f32_bf16 v100, v110, v162
    buffer_load_dwordx4 v23, s[16:19], s91 offen offset:3072 lds
    v_dot2c_f32_bf16 v101, v110, v163
    v_dot2c_f32_bf16 v102, v111, v162
    v_dot2c_f32_bf16 v103, v111, v163
    v_lshlrev_b32 v112, 16, v120
    v_and_b32 v113, s39, v120
    s_waitcnt vmcnt(8)
    ds_read_b128 a[100:103], v204 offset:0
    ds_read_b128 a[108:111], v205 offset:0
    ds_read_b128 a[116:119], v206 offset:0
    ds_read_b128 a[124:127], v207 offset:0
    v_lshlrev_b32 v114, 16, v121
    v_and_b32 v115, s39, v121
    s_mul_i32 s6, s58, 512
    s_add_u32 s6, s6, 14680064
    v_lshrrev_b32 v244, 3, v2
    v_mul_u32_u24 v244, 0, v244
    v_lshl_add_u32 v24, v2, 4, v244
    buffer_load_dwordx4 v[244:247], v24, s[28:31], s6 offen sc1
    s_waitcnt lgkmcnt(4)
    s_xor_b32 s91, s95, 4195072
    s_add_u32 m0, s7, 4096
    s_nop 0
    buffer_load_dwordx4 v20, s[16:19], s91 offen offset:0 lds
    v_lshlrev_b32 v116, 16, v122
    v_and_b32 v117, s39, v122
    v_lshlrev_b32 v118, 16, v123
    buffer_load_dwordx4 v21, s[16:19], s91 offen offset:1024 lds
    v_and_b32 v119, s39, v123
    v_dot2c_f32_bf16 v112, v124, v162
    v_dot2c_f32_bf16 v113, v124, v163
    v_dot2c_f32_bf16 v114, v125, v162
    v_dot2c_f32_bf16 v115, v125, v163
    buffer_load_dwordx4 v22, s[16:19], s91 offen offset:2048 lds
    v_dot2c_f32_bf16 v116, v126, v162
    v_dot2c_f32_bf16 v117, v126, v163
    v_dot2c_f32_bf16 v118, v127, v162
    v_dot2c_f32_bf16 v119, v127, v163
    v_lshlrev_b32 v128, 16, v136
    buffer_load_dwordx4 v23, s[16:19], s91 offen offset:3072 lds
    v_and_b32 v129, s39, v136
    v_lshlrev_b32 v130, 16, v137
    v_and_b32 v131, s39, v137
    v_lshlrev_b32 v132, 16, v138
    v_and_b32 v133, s39, v138
    s_waitcnt lgkmcnt(0)
    s_xor_b32 s91, s95, 768
    s_add_u32 m0, s7, 65536
    s_nop 0
    buffer_load_dwordx4 v20, s[16:19], s91 offen offset:0 lds
    v_lshlrev_b32 v134, 16, v139
    v_and_b32 v135, s39, v139
    v_dot2c_f32_bf16 v128, v140, v162
    buffer_load_dwordx4 v21, s[16:19], s91 offen offset:1024 lds
    v_dot2c_f32_bf16 v129, v140, v163
    v_dot2c_f32_bf16 v130, v141, v162
    v_dot2c_f32_bf16 v131, v141, v163
    v_dot2c_f32_bf16 v132, v142, v162
    v_dot2c_f32_bf16 v133, v142, v163
    buffer_load_dwordx4 v22, s[16:19], s91 offen offset:2048 lds
    v_dot2c_f32_bf16 v134, v143, v162
    v_dot2c_f32_bf16 v135, v143, v163
    v_pk_mul_f32 v[104:105], v[96:97], v[96:97]
    v_pk_mul_f32 v[106:107], v[98:99], v[98:99]
    v_pk_mul_f32 v[108:109], v[100:101], v[100:101]
    buffer_load_dwordx4 v23, s[16:19], s91 offen offset:3072 lds
    v_pk_mul_f32 v[110:111], v[102:103], v[102:103]
    v_pk_fma_f32 v[104:105], v[104:105], s[4:5], v[174:175] op_sel_hi:[1,1,0]
    v_pk_fma_f32 v[106:107], v[106:107], s[4:5], v[174:175] op_sel_hi:[1,1,0]
    v_pk_fma_f32 v[108:109], v[108:109], s[4:5], v[174:175] op_sel_hi:[1,1,0]
    v_pk_fma_f32 v[110:111], v[110:111], s[4:5], v[174:175] op_sel_hi:[1,1,0]
    s_waitcnt vmcnt(8)
L_ag_18:
    v_xor_b32 v244, s64, v244
    v_xor_b32 v245, s64, v245
    v_xor_b32 v246, s64, v246
    v_xor_b32 v247, s64, v247
    v_or3_b32 v244, v244, v245, v246
    v_or_b32 v244, v244, v247
    v_cmp_ne_u32 vcc, 0, v244
    s_cbranch_vccnz L_rt_19
L_rc_20:
    s_add_u32 m0, s66, 0
    s_add_u32 s89, s87, 0
    buffer_load_dwordx4 v4, s[28:31], s89 offen offset:0 sc1 lds
    v_pk_mul_f32 v[104:105], v[104:105], v[96:97]
    buffer_load_dwordx4 v4, s[28:31], s89 offen offset:1024 sc1 lds
    v_pk_mul_f32 v[106:107], v[106:107], v[98:99]
    v_pk_mul_f32 v[108:109], v[108:109], v[100:101]
    v_pk_mul_f32 v[110:111], v[110:111], v[102:103]
    v_exp_f32 v104, v104
    buffer_load_dwordx4 v4, s[28:31], s89 offen offset:2048 sc1 lds
    v_exp_f32 v105, v105
    v_exp_f32 v106, v106
    v_exp_f32 v107, v107
    buffer_load_dwordx4 v4, s[28:31], s89 offen offset:3072 sc1 lds
    v_exp_f32 v108, v108
    v_exp_f32 v109, v109
    s_add_u32 m0, s66, 16384
    s_add_u32 s89, s87, 4096
    buffer_load_dwordx4 v4, s[28:31], s89 offen offset:0 sc1 lds
    v_exp_f32 v110, v110
    v_exp_f32 v111, v111
    buffer_load_dwordx4 v4, s[28:31], s89 offen offset:1024 sc1 lds
    v_pk_add_f32 v[104:105], v[104:105], v[174:175] op_sel:[0,1] op_sel_hi:[1,1]
    v_pk_add_f32 v[106:107], v[106:107], v[174:175] op_sel:[0,1] op_sel_hi:[1,1]
    v_pk_add_f32 v[108:109], v[108:109], v[174:175] op_sel:[0,1] op_sel_hi:[1,1]
    v_pk_add_f32 v[110:111], v[110:111], v[174:175] op_sel:[0,1] op_sel_hi:[1,1]
    buffer_load_dwordx4 v4, s[28:31], s89 offen offset:2048 sc1 lds
    v_rcp_f32 v104, v104
    v_rcp_f32 v105, v105
    v_rcp_f32 v106, v106
    buffer_load_dwordx4 v4, s[28:31], s89 offen offset:3072 sc1 lds
    v_rcp_f32 v107, v107
    v_rcp_f32 v108, v108
    ds_read_b128 a[160:163], v200 offset:32768
    ds_read_b128 a[168:171], v201 offset:32768
    ds_read_b128 a[176:179], v202 offset:32768
    ds_read_b128 a[184:187], v203 offset:32768
    v_rcp_f32 v109, v109
    s_add_u32 m0, s66, 32768
    s_add_u32 s89, s87, 8192
    buffer_load_dwordx4 v4, s[28:31], s89 offen offset:0 sc1 lds
    v_rcp_f32 v110, v110
    v_rcp_f32 v111, v111
    buffer_load_dwordx4 v4, s[28:31], s89 offen offset:1024 sc1 lds
    v_pk_mul_f32 v[96:97], v[96:97], v[104:105]
    v_pk_mul_f32 v[98:99], v[98:99], v[106:107]
    v_pk_mul_f32 v[100:101], v[100:101], v[108:109]
    v_pk_mul_f32 v[102:103], v[102:103], v[110:111]
    buffer_load_dwordx4 v4, s[28:31], s89 offen offset:2048 sc1 lds
    v_pk_mul_f32 v[120:121], v[112:113], v[112:113]
    v_pk_mul_f32 v[122:123], v[114:115], v[114:115]
    v_pk_mul_f32 v[124:125], v[116:117], v[116:117]
    v_pk_mul_f32 v[126:127], v[118:119], v[118:119]
    v_pk_fma_f32 v[120:121], v[120:121], s[4:5], v[174:175] op_sel_hi:[1,1,0]
    buffer_load_dwordx4 v4, s[28:31], s89 offen offset:3072 sc1 lds
    v_pk_fma_f32 v[122:123], v[122:123], s[4:5], v[174:175] op_sel_hi:[1,1,0]
    v_pk_fma_f32 v[124:125], v[124:125], s[4:5], v[174:175] op_sel_hi:[1,1,0]
    v_pk_fma_f32 v[126:127], v[126:127], s[4:5], v[174:175] op_sel_hi:[1,1,0]
    v_pk_mul_f32 v[120:121], v[120:121], v[112:113]
    v_pk_mul_f32 v[122:123], v[122:123], v[114:115]
    s_waitcnt vmcnt(16)
    ds_read_b128 a[228:231], v200 offset:4096
    ds_read_b128 a[236:239], v201 offset:4096
    ds_read_b128 a[244:247], v202 offset:4096
    ds_read_b128 a[252:255], v203 offset:4096
    v_pk_mul_f32 v[124:125], v[124:125], v[116:117]
    v_pk_mul_f32 v[126:127], v[126:127], v[118:119]
    s_add_u32 m0, s66, 49152
    s_add_u32 s89, s87, 12288
    buffer_load_dwordx4 v4, s[28:31], s89 offen offset:0 sc1 lds
    v_exp_f32 v120, v120
    v_exp_f32 v121, v121
    buffer_load_dwordx4 v4, s[28:31], s89 offen offset:1024 sc1 lds
    v_exp_f32 v122, v122
    v_exp_f32 v123, v123
    buffer_load_dwordx4 v4, s[28:31], s89 offen offset:2048 sc1 lds
    v_exp_f32 v124, v124
    v_exp_f32 v125, v125
    v_exp_f32 v126, v126
    buffer_load_dwordx4 v4, s[28:31], s89 offen offset:3072 sc1 lds
    v_exp_f32 v127, v127
    v_pk_add_f32 v[120:121], v[120:121], v[174:175] op_sel:[0,1] op_sel_hi:[1,1]
    v_pk_add_f32 v[122:123], v[122:123], v[174:175] op_sel:[0,1] op_sel_hi:[1,1]
    ds_read_b128 a[192:195], v204 offset:4096
    ds_read_b128 a[200:203], v205 offset:4096
    ds_read_b128 a[208:211], v206 offset:4096
    ds_read_b128 a[216:219], v207 offset:4096
    v_pk_add_f32 v[124:125], v[124:125], v[174:175] op_sel:[0,1] op_sel_hi:[1,1]
    v_pk_add_f32 v[126:127], v[126:127], v[174:175] op_sel:[0,1] op_sel_hi:[1,1]
    v_rcp_f32 v120, v120
    v_rcp_f32 v121, v121
    v_rcp_f32 v122, v122
    v_rcp_f32 v123, v123
    v_rcp_f32 v124, v124
    v_rcp_f32 v125, v125
    v_rcp_f32 v126, v126
    v_rcp_f32 v127, v127
    v_pk_mul_f32 v[112:113], v[112:113], v[120:121]
    v_pk_mul_f32 v[114:115], v[114:115], v[122:123]
    v_pk_mul_f32 v[116:117], v[116:117], v[124:125]
    v_pk_mul_f32 v[118:119], v[118:119], v[126:127]
    s_waitcnt lgkmcnt(0)
    s_waitcnt vmcnt(12)
    ds_read_b64_tr_b16 v[176:177], v160 offset:0
    ds_read_b64_tr_b16 v[178:179], v160 offset:1024
    ds_read_b64_tr_b16 v[180:181], v160 offset:8
    ds_read_b64_tr_b16 v[182:183], v160 offset:1032
    ds_read_b64_tr_b16 v[184:185], v16 offset:0
    ds_read_b64_tr_b16 v[186:187], v16 offset:1024
    ds_read_b64_tr_b16 v[188:189], v16 offset:8
    ds_read_b64_tr_b16 v[190:191], v16 offset:1032
    s_waitcnt lgkmcnt(0)
    v_mfma_f32_16x16x32_bf16 v[32:35], v[176:179], a[0:3], 0
    s_add_u32 m0, s66, 0
    s_add_u32 s89, s97, 0
    buffer_load_dwordx4 v4, s[28:31], s89 offen offset:0 sc1 lds
    v_mfma_f32_16x16x32_bf16 v[36:39], v[180:183], a[0:3], 0
    ds_read_b128 a[96:99], v171 offset:36864
    v_mfma_f32_16x16x32_bf16 v[40:43], v[176:179], a[64:67], 0
    s_waitcnt vmcnt(9)
    v_mfma_f32_16x16x32_bf16 v[44:47], v[180:183], a[64:67], 0
    ds_read_b64_tr_b16 v[192:193], v160 offset:16384
    ds_read_b64_tr_b16 v[194:195], v160 offset:17408
    v_xor_b32 v9, 32, v171
    v_mfma_f32_16x16x32_bf16 v[48:51], v[176:179], a[128:131], 0
    buffer_load_dwordx4 v4, s[28:31], s89 offen offset:1024 sc1 lds
    ds_read_b64_tr_b16 v[196:197], v160 offset:16392
    v_mfma_f32_16x16x32_bf16 v[52:55], v[180:183], a[128:131], 0
    ds_read_b64_tr_b16 v[198:199], v160 offset:17416
    ds_read_b128 a[104:107], v9 offset:36864
    v_mfma_f32_16x16x32_bf16 v[56:59], v[176:179], a[192:195], 0
    ds_read_b64_tr_b16 v[200:201], v16 offset:16384
    ds_read_b64_tr_b16 v[202:203], v16 offset:17408
    v_mfma_f32_16x16x32_bf16 v[60:63], v[180:183], a[192:195], 0
    v_xor_b32 v9, 64, v171
    v_mfma_f32_16x16x32_bf16 v[32:35], v[184:187], a[4:7], v[32:35]
    buffer_load_dwordx4 v4, s[28:31], s89 offen offset:2048 sc1 lds
    ds_read_b64_tr_b16 v[204:205], v16 offset:16392
    v_mfma_f32_16x16x32_bf16 v[36:39], v[188:191], a[4:7], v[36:39]
    ds_read_b64_tr_b16 v[206:207], v16 offset:17416
    ds_read_b128 a[112:115], v9 offset:36864
    v_mfma_f32_16x16x32_bf16 v[40:43], v[184:187], a[68:71], v[40:43]
    v_xor_b32 v9, 96, v171
    ds_read_b128 a[120:123], v9 offset:36864
    v_mfma_f32_16x16x32_bf16 v[44:47], v[188:191], a[68:71], v[44:47]
    ds_read_b128 a[224:227], v171 offset:0
    v_mfma_f32_16x16x32_bf16 v[48:51], v[184:187], a[132:135], v[48:51]
    buffer_load_dwordx4 v4, s[28:31], s89 offen offset:3072 sc1 lds
    v_xor_b32 v9, 32, v171
    v_mfma_f32_16x16x32_bf16 v[52:55], v[188:191], a[132:135], v[52:55]
    ds_read_b128 a[232:235], v9 offset:0
    v_xor_b32 v9, 64, v171
    v_mfma_f32_16x16x32_bf16 v[56:59], v[184:187], a[196:199], v[56:59]
    ds_read_b128 a[240:243], v9 offset:0
    v_xor_b32 v9, 96, v171
    v_mfma_f32_16x16x32_bf16 v[60:63], v[188:191], a[196:199], v[60:63]
    ds_read_b128 a[248:251], v9 offset:0
    s_waitcnt lgkmcnt(6)
    v_mfma_f32_16x16x32_bf16 v[32:35], v[192:195], a[8:11], v[32:35]
    s_add_u32 m0, s66, 16384
    s_add_u32 s89, s97, 4096
    buffer_load_dwordx4 v4, s[28:31], s89 offen offset:0 sc1 lds
    v_mfma_f32_16x16x32_bf16 v[36:39], v[196:199], a[8:11], v[36:39]
    ds_read_b128 a[164:167], v17 offset:0
    v_mfma_f32_16x16x32_bf16 v[40:43], v[192:195], a[72:75], v[40:43]
    s_waitcnt vmcnt(9)
    v_mfma_f32_16x16x32_bf16 v[44:47], v[196:199], a[72:75], v[44:47]
    ds_read_b64_tr_b16 v[176:177], v160 offset:32768
    ds_read_b64_tr_b16 v[178:179], v160 offset:33792
    v_xor_b32 v9, 32, v17
    v_mfma_f32_16x16x32_bf16 v[48:51], v[192:195], a[136:139], v[48:51]
    buffer_load_dwordx4 v4, s[28:31], s89 offen offset:1024 sc1 lds
    ds_read_b64_tr_b16 v[180:181], v160 offset:32776
    v_mfma_f32_16x16x32_bf16 v[52:55], v[196:199], a[136:139], v[52:55]
    ds_read_b64_tr_b16 v[182:183], v160 offset:33800
    ds_read_b128 a[172:175], v9 offset:0
    v_mfma_f32_16x16x32_bf16 v[56:59], v[192:195], a[200:203], v[56:59]
    ds_read_b64_tr_b16 v[184:185], v16 offset:32768
    ds_read_b64_tr_b16 v[186:187], v16 offset:33792
    v_mfma_f32_16x16x32_bf16 v[60:63], v[196:199], a[200:203], v[60:63]
    v_xor_b32 v9, 64, v17
    v_mfma_f32_16x16x32_bf16 v[32:35], v[200:203], a[12:15], v[32:35]
    buffer_load_dwordx4 v4, s[28:31], s89 offen offset:2048 sc1 lds
    ds_read_b64_tr_b16 v[188:189], v16 offset:32776
    v_mfma_f32_16x16x32_bf16 v[36:39], v[204:207], a[12:15], v[36:39]
    ds_read_b64_tr_b16 v[190:191], v16 offset:33800
    ds_read_b128 a[180:183], v9 offset:0
    v_mfma_f32_16x16x32_bf16 v[40:43], v[200:203], a[76:79], v[40:43]
    v_xor_b32 v9, 96, v17
    ds_read_b128 a[188:191], v9 offset:0
    v_mfma_f32_16x16x32_bf16 v[44:47], v[204:207], a[76:79], v[44:47]
    v_lshl_add_u32 v12, v3, 30, v4
    v_mfma_f32_16x16x32_bf16 v[48:51], v[200:203], a[140:143], v[48:51]
    buffer_load_dwordx4 v4, s[28:31], s89 offen offset:3072 sc1 lds
    v_bfe_u32 v6, v1, 2, 2
    v_mfma_f32_16x16x32_bf16 v[52:55], v[204:207], a[140:143], v[52:55]
    v_lshlrev_b32 v6, 6, v6
    v_bfe_u32 v7, v1, 4, 1
    v_mfma_f32_16x16x32_bf16 v[56:59], v[200:203], a[204:207], v[56:59]
    v_lshl_add_u32 v6, v7, 9, v6
    v_sub_u32 v28, v160, v6
    v_mfma_f32_16x16x32_bf16 v[60:63], v[204:207], a[204:207], v[60:63]
    v_xor_b32 v29, 32, v28
    s_waitcnt lgkmcnt(2)
    v_mfma_f32_16x16x32_bf16 v[32:35], v[176:179], a[16:19], v[32:35]
    s_add_u32 m0, s66, 32768
    s_add_u32 s89, s97, 8192
    v_mfma_f32_16x16x32_bf16 v[36:39], v[180:183], a[16:19], v[36:39]
    buffer_load_dwordx4 v4, s[28:31], s89 offen offset:0 sc1 lds
    s_mul_i32 s70, s56, 47104
    v_mfma_f32_16x16x32_bf16 v[40:43], v[176:179], a[80:83], v[40:43]
    s_waitcnt vmcnt(9)
    v_mfma_f32_16x16x32_bf16 v[44:47], v[180:183], a[80:83], v[44:47]
    ds_read_b64_tr_b16 v[192:193], v160 offset:49152
    ds_read_b64_tr_b16 v[194:195], v160 offset:50176
    s_add_u32 s70, s70, 65536
    v_mfma_f32_16x16x32_bf16 v[48:51], v[176:179], a[144:147], v[48:51]
    buffer_load_dwordx4 v4, s[28:31], s89 offen offset:1024 sc1 lds
    ds_read_b64_tr_b16 v[196:197], v160 offset:49160
    v_mfma_f32_16x16x32_bf16 v[52:55], v[180:183], a[144:147], v[52:55]
    ds_read_b64_tr_b16 v[198:199], v160 offset:50184
    v_add_u32 v25, s70, v4
    v_mfma_f32_16x16x32_bf16 v[56:59], v[176:179], a[208:211], v[56:59]
    ds_read_b64_tr_b16 v[200:201], v16 offset:49152
    ds_read_b64_tr_b16 v[202:203], v16 offset:50176
    v_mfma_f32_16x16x32_bf16 v[60:63], v[180:183], a[208:211], v[60:63]
    v_mul_u32_u24 v6, 80, v2
    v_mfma_f32_16x16x32_bf16 v[32:35], v[184:187], a[20:23], v[32:35]
    buffer_load_dwordx4 v4, s[28:31], s89 offen offset:2048 sc1 lds
    ds_read_b64_tr_b16 v[204:205], v16 offset:49160
    v_mfma_f32_16x16x32_bf16 v[36:39], v[188:191], a[20:23], v[36:39]
    ds_read_b64_tr_b16 v[206:207], v16 offset:50184
    v_lshl_add_u32 v6, v3, 4, v6
    v_mfma_f32_16x16x32_bf16 v[40:43], v[184:187], a[84:87], v[40:43]
    v_add_u32 v27, s66, v6
    v_lshrrev_b32 v6, 2, v1
    v_mfma_f32_16x16x32_bf16 v[44:47], v[188:191], a[84:87], v[44:47]
    v_and_b32 v7, 3, v1
    v_mfma_f32_16x16x32_bf16 v[48:51], v[184:187], a[148:151], v[48:51]
    buffer_load_dwordx4 v4, s[28:31], s89 offen offset:3072 sc1 lds
    v_mul_u32_u24 v8, 80, v6
    v_mfma_f32_16x16x32_bf16 v[52:55], v[188:191], a[148:151], v[52:55]
    v_lshl_add_u32 v8, v7, 4, v8
    v_add_u32 v14, s66, v8
    v_mfma_f32_16x16x32_bf16 v[56:59], v[184:187], a[212:215], v[56:59]
    v_lshlrev_b32 v6, 16, v6
    v_lshl_add_u32 v15, v7, 4, v6
    v_mfma_f32_16x16x32_bf16 v[60:63], v[188:191], a[212:215], v[60:63]
    s_lshl_b32 s70, s61, 10
    s_waitcnt lgkmcnt(0)
    v_mfma_f32_16x16x32_bf16 v[32:35], v[192:195], a[24:27], v[32:35]
    s_add_u32 m0, s66, 49152
    s_add_u32 s89, s97, 12288
    v_mfma_f32_16x16x32_bf16 v[36:39], v[196:199], a[24:27], v[36:39]
    buffer_load_dwordx4 v4, s[28:31], s89 offen offset:0 sc1 lds
    s_lshl_b32 s71, s58, 7
    v_mfma_f32_16x16x32_bf16 v[40:43], v[192:195], a[88:91], v[40:43]
    s_waitcnt vmcnt(9)
    v_mfma_f32_16x16x32_bf16 v[44:47], v[196:199], a[88:91], v[44:47]
    ds_read_b64_tr_b16 v[176:177], v160 offset:0
    ds_read_b64_tr_b16 v[178:179], v160 offset:1024
    s_add_u32 s70, s70, s71
    v_mfma_f32_16x16x32_bf16 v[48:51], v[192:195], a[152:155], v[48:51]
    buffer_load_dwordx4 v4, s[28:31], s89 offen offset:1024 sc1 lds
    ds_read_b64_tr_b16 v[180:181], v160 offset:8
    v_mfma_f32_16x16x32_bf16 v[52:55], v[196:199], a[152:155], v[52:55]
    ds_read_b64_tr_b16 v[182:183], v160 offset:1032
    s_lshl_b32 s71, s56, 6
    v_mfma_f32_16x16x32_bf16 v[56:59], v[192:195], a[216:219], v[56:59]
    ds_read_b64_tr_b16 v[184:185], v16 offset:0
    ds_read_b64_tr_b16 v[186:187], v16 offset:1024
    v_mfma_f32_16x16x32_bf16 v[60:63], v[196:199], a[216:219], v[60:63]
    s_add_u32 s76, s70, s71
    v_mfma_f32_16x16x32_bf16 v[32:35], v[200:203], a[28:31], v[32:35]
    buffer_load_dwordx4 v4, s[28:31], s89 offen offset:2048 sc1 lds
    ds_read_b64_tr_b16 v[188:189], v16 offset:8
    v_mfma_f32_16x16x32_bf16 v[36:39], v[204:207], a[28:31], v[36:39]
    ds_read_b64_tr_b16 v[190:191], v16 offset:1032
    s_add_u32 s77, s76, 1048576
    v_mfma_f32_16x16x32_bf16 v[40:43], v[200:203], a[92:95], v[40:43]
    s_lshl_b32 s38, s54, 10
    s_add_u32 s96, s41, s38
    v_mfma_f32_16x16x32_bf16 v[44:47], v[204:207], a[92:95], v[44:47]
    v_mul_f32 v136, v128, v128
    v_mfma_f32_16x16x32_bf16 v[48:51], v[200:203], a[156:159], v[48:51]
    buffer_load_dwordx4 v4, s[28:31], s89 offen offset:3072 sc1 lds
    v_mul_f32 v137, v129, v129
    v_mfma_f32_16x16x32_bf16 v[52:55], v[204:207], a[156:159], v[52:55]
    v_mul_f32 v138, v130, v130
    v_mul_f32 v139, v131, v131
    v_mfma_f32_16x16x32_bf16 v[56:59], v[200:203], a[220:223], v[56:59]
    v_mul_f32 v140, v132, v132
    v_mul_f32 v141, v133, v133
    v_mfma_f32_16x16x32_bf16 v[60:63], v[204:207], a[220:223], v[60:63]
    v_mul_f32 v142, v134, v134
    s_waitcnt lgkmcnt(0)
    s_barrier
    v_mfma_f32_16x16x32_bf16 v[32:35], v[176:179], a[32:35], v[32:35]
    s_add_u32 m0, s66, 0
    s_add_u32 s89, s87, 131072
    v_mfma_f32_16x16x32_bf16 v[36:39], v[180:183], a[32:35], v[36:39]
    buffer_load_dwordx4 v4, s[28:31], s89 offen offset:0 sc1 lds
    v_mul_f32 v143, v135, v135
    v_mfma_f32_16x16x32_bf16 v[40:43], v[176:179], a[96:99], v[40:43]
    s_waitcnt vmcnt(9)
    v_mfma_f32_16x16x32_bf16 v[44:47], v[180:183], a[96:99], v[44:47]
    ds_read_b64_tr_b16 v[192:193], v160 offset:16384
    ds_read_b64_tr_b16 v[194:195], v160 offset:17408
    v_fma_f32 v136, v136, s4, v174
    v_mfma_f32_16x16x32_bf16 v[48:51], v[176:179], a[160:163], v[48:51]
    buffer_load_dwordx4 v4, s[28:31], s89 offen offset:1024 sc1 lds
    ds_read_b64_tr_b16 v[196:197], v160 offset:16392
    v_mfma_f32_16x16x32_bf16 v[52:55], v[180:183], a[160:163], v[52:55]
    ds_read_b64_tr_b16 v[198:199], v160 offset:17416
    v_fma_f32 v137, v137, s4, v174
    v_mfma_f32_16x16x32_bf16 v[56:59], v[176:179], a[224:227], v[56:59]
    ds_read_b64_tr_b16 v[200:201], v16 offset:16384
    ds_read_b64_tr_b16 v[202:203], v16 offset:17408
    v_mfma_f32_16x16x32_bf16 v[60:63], v[180:183], a[224:227], v[60:63]
    v_fma_f32 v138, v138, s4, v174
    v_mfma_f32_16x16x32_bf16 v[32:35], v[184:187], a[36:39], v[32:35]
    buffer_load_dwordx4 v4, s[28:31], s89 offen offset:2048 sc1 lds
    ds_read_b64_tr_b16 v[204:205], v16 offset:16392
    v_mfma_f32_16x16x32_bf16 v[36:39], v[188:191], a[36:39], v[36:39]
    ds_read_b64_tr_b16 v[206:207], v16 offset:17416
    v_fma_f32 v139, v139, s4, v174
    v_mfma_f32_16x16x32_bf16 v[40:43], v[184:187], a[100:103], v[40:43]
    v_fma_f32 v140, v140, s4, v174
    v_fma_f32 v141, v141, s4, v174
    v_mfma_f32_16x16x32_bf16 v[44:47], v[188:191], a[100:103], v[44:47]
    v_fma_f32 v142, v142, s4, v174
    v_mfma_f32_16x16x32_bf16 v[48:51], v[184:187], a[164:167], v[48:51]
    buffer_load_dwordx4 v4, s[28:31], s89 offen offset:3072 sc1 lds
    v_fma_f32 v143, v143, s4, v174
    v_mfma_f32_16x16x32_bf16 v[52:55], v[188:191], a[164:167], v[52:55]
    v_mul_f32 v136, v136, v128
    v_mul_f32 v137, v137, v129
    v_mfma_f32_16x16x32_bf16 v[56:59], v[184:187], a[228:231], v[56:59]
    v_mul_f32 v138, v138, v130
    v_mul_f32 v139, v139, v131
    v_mfma_f32_16x16x32_bf16 v[60:63], v[188:191], a[228:231], v[60:63]
    v_mul_f32 v140, v140, v132
    s_waitcnt lgkmcnt(0)
    v_mfma_f32_16x16x32_bf16 v[32:35], v[192:195], a[40:43], v[32:35]
    s_add_u32 m0, s66, 16384
    s_add_u32 s89, s87, 135168
    v_mfma_f32_16x16x32_bf16 v[36:39], v[196:199], a[40:43], v[36:39]
    buffer_load_dwordx4 v4, s[28:31], s89 offen offset:0 sc1 lds
    v_mul_f32 v141, v141, v133
    v_mfma_f32_16x16x32_bf16 v[40:43], v[192:195], a[104:107], v[40:43]
    s_waitcnt vmcnt(9)
    v_mfma_f32_16x16x32_bf16 v[44:47], v[196:199], a[104:107], v[44:47]
    ds_read_b64_tr_b16 v[176:177], v160 offset:32768
    ds_read_b64_tr_b16 v[178:179], v160 offset:33792
    v_mul_f32 v142, v142, v134
    v_mfma_f32_16x16x32_bf16 v[48:51], v[192:195], a[168:171], v[48:51]
    buffer_load_dwordx4 v4, s[28:31], s89 offen offset:1024 sc1 lds
    ds_read_b64_tr_b16 v[180:181], v160 offset:32776
    v_mfma_f32_16x16x32_bf16 v[52:55], v[196:199], a[168:171], v[52:55]
    ds_read_b64_tr_b16 v[182:183], v160 offset:33800
    v_mul_f32 v143, v143, v135
    v_mfma_f32_16x16x32_bf16 v[56:59], v[192:195], a[232:235], v[56:59]
    ds_read_b64_tr_b16 v[184:185], v16 offset:32768
    ds_read_b64_tr_b16 v[186:187], v16 offset:33792
    v_mfma_f32_16x16x32_bf16 v[60:63], v[196:199], a[232:235], v[60:63]
    v_exp_f32 v136, v136
    v_mfma_f32_16x16x32_bf16 v[32:35], v[200:203], a[44:47], v[32:35]
    buffer_load_dwordx4 v4, s[28:31], s89 offen offset:2048 sc1 lds
    ds_read_b64_tr_b16 v[188:189], v16 offset:32776
    v_mfma_f32_16x16x32_bf16 v[36:39], v[204:207], a[44:47], v[36:39]
    ds_read_b64_tr_b16 v[190:191], v16 offset:33800
    v_exp_f32 v137, v137
    v_mfma_f32_16x16x32_bf16 v[40:43], v[200:203], a[108:111], v[40:43]
    v_exp_f32 v138, v138
    v_mfma_f32_16x16x32_bf16 v[44:47], v[204:207], a[108:111], v[44:47]
    v_exp_f32 v139, v139
    v_mfma_f32_16x16x32_bf16 v[48:51], v[200:203], a[172:175], v[48:51]
    buffer_load_dwordx4 v4, s[28:31], s89 offen offset:3072 sc1 lds
    v_exp_f32 v140, v140
    v_mfma_f32_16x16x32_bf16 v[52:55], v[204:207], a[172:175], v[52:55]
    v_exp_f32 v141, v141
    v_mfma_f32_16x16x32_bf16 v[56:59], v[200:203], a[236:239], v[56:59]
    v_exp_f32 v142, v142
    v_mfma_f32_16x16x32_bf16 v[60:63], v[204:207], a[236:239], v[60:63]
    v_exp_f32 v143, v143
    s_waitcnt lgkmcnt(0)
    v_mfma_f32_16x16x32_bf16 v[32:35], v[176:179], a[48:51], v[32:35]
    s_add_u32 m0, s66, 32768
    s_add_u32 s89, s87, 139264
    v_mfma_f32_16x16x32_bf16 v[36:39], v[180:183], a[48:51], v[36:39]
    buffer_load_dwordx4 v4, s[28:31], s89 offen offset:0 sc1 lds
    v_add_f32 v136, 1.0, v136
    v_mfma_f32_16x16x32_bf16 v[40:43], v[176:179], a[112:115], v[40:43]
    s_waitcnt vmcnt(9)
    v_mfma_f32_16x16x32_bf16 v[44:47], v[180:183], a[112:115], v[44:47]
    ds_read_b64_tr_b16 v[192:193], v160 offset:49152
    ds_read_b64_tr_b16 v[194:195], v160 offset:50176
    v_add_f32 v137, 1.0, v137
    v_mfma_f32_16x16x32_bf16 v[48:51], v[176:179], a[176:179], v[48:51]
    buffer_load_dwordx4 v4, s[28:31], s89 offen offset:1024 sc1 lds
    ds_read_b64_tr_b16 v[196:197], v160 offset:49160
    v_mfma_f32_16x16x32_bf16 v[52:55], v[180:183], a[176:179], v[52:55]
    ds_read_b64_tr_b16 v[198:199], v160 offset:50184
    v_add_f32 v138, 1.0, v138
    v_mfma_f32_16x16x32_bf16 v[56:59], v[176:179], a[240:243], v[56:59]
    ds_read_b64_tr_b16 v[200:201], v16 offset:49152
    ds_read_b64_tr_b16 v[202:203], v16 offset:50176
    v_mfma_f32_16x16x32_bf16 v[60:63], v[180:183], a[240:243], v[60:63]
    v_add_f32 v139, 1.0, v139
    v_mfma_f32_16x16x32_bf16 v[32:35], v[184:187], a[52:55], v[32:35]
    buffer_load_dwordx4 v4, s[28:31], s89 offen offset:2048 sc1 lds
    ds_read_b64_tr_b16 v[204:205], v16 offset:49160
    v_mfma_f32_16x16x32_bf16 v[36:39], v[188:191], a[52:55], v[36:39]
    ds_read_b64_tr_b16 v[206:207], v16 offset:50184
    v_add_f32 v140, 1.0, v140
    v_mfma_f32_16x16x32_bf16 v[40:43], v[184:187], a[116:119], v[40:43]
    v_add_f32 v141, 1.0, v141
    v_add_f32 v142, 1.0, v142
    v_mfma_f32_16x16x32_bf16 v[44:47], v[188:191], a[116:119], v[44:47]
    v_add_f32 v143, 1.0, v143
    v_mfma_f32_16x16x32_bf16 v[48:51], v[184:187], a[180:183], v[48:51]
    buffer_load_dwordx4 v4, s[28:31], s89 offen offset:3072 sc1 lds
    v_rcp_f32 v136, v136
    v_mfma_f32_16x16x32_bf16 v[52:55], v[188:191], a[180:183], v[52:55]
    v_rcp_f32 v137, v137
    v_mfma_f32_16x16x32_bf16 v[56:59], v[184:187], a[244:247], v[56:59]
    v_rcp_f32 v138, v138
    v_mfma_f32_16x16x32_bf16 v[60:63], v[188:191], a[244:247], v[60:63]
    v_rcp_f32 v139, v139
    s_waitcnt lgkmcnt(0)
    v_mfma_f32_16x16x32_bf16 v[32:35], v[192:195], a[56:59], v[32:35]
    s_add_u32 m0, s66, 49152
    s_add_u32 s89, s87, 143360
    v_mfma_f32_16x16x32_bf16 v[36:39], v[196:199], a[56:59], v[36:39]
    buffer_load_dwordx4 v4, s[28:31], s89 offen offset:0 sc1 lds
    v_rcp_f32 v140, v140
    v_mfma_f32_16x16x32_bf16 v[40:43], v[192:195], a[120:123], v[40:43]
    s_waitcnt vmcnt(9)
    v_mfma_f32_16x16x32_bf16 v[44:47], v[196:199], a[120:123], v[44:47]
    ds_read_b64_tr_b16 v[176:177], v160 offset:0
    ds_read_b64_tr_b16 v[178:179], v160 offset:1024
    v_rcp_f32 v141, v141
    v_mfma_f32_16x16x32_bf16 v[48:51], v[192:195], a[184:187], v[48:51]
    buffer_load_dwordx4 v4, s[28:31], s89 offen offset:1024 sc1 lds
    ds_read_b64_tr_b16 v[180:181], v160 offset:8
    v_mfma_f32_16x16x32_bf16 v[52:55], v[196:199], a[184:187], v[52:55]
    ds_read_b64_tr_b16 v[182:183], v160 offset:1032
    v_rcp_f32 v142, v142
    v_mfma_f32_16x16x32_bf16 v[56:59], v[192:195], a[248:251], v[56:59]
    ds_read_b64_tr_b16 v[184:185], v16 offset:0
    ds_read_b64_tr_b16 v[186:187], v16 offset:1024
    v_mfma_f32_16x16x32_bf16 v[60:63], v[196:199], a[248:251], v[60:63]
    v_rcp_f32 v143, v143
    v_mfma_f32_16x16x32_bf16 v[32:35], v[200:203], a[60:63], v[32:35]
    buffer_load_dwordx4 v4, s[28:31], s89 offen offset:2048 sc1 lds
    ds_read_b64_tr_b16 v[188:189], v16 offset:8
    v_mfma_f32_16x16x32_bf16 v[36:39], v[204:207], a[60:63], v[36:39]
    ds_read_b64_tr_b16 v[190:191], v16 offset:1032
    v_mul_f32 v128, v128, v136
    v_mfma_f32_16x16x32_bf16 v[40:43], v[200:203], a[124:127], v[40:43]
    v_mul_f32 v129, v129, v137
    v_mul_f32 v130, v130, v138
    v_mfma_f32_16x16x32_bf16 v[44:47], v[204:207], a[124:127], v[44:47]
    v_mul_f32 v131, v131, v139
    v_mfma_f32_16x16x32_bf16 v[48:51], v[200:203], a[188:191], v[48:51]
    buffer_load_dwordx4 v4, s[28:31], s89 offen offset:3072 sc1 lds
    v_mul_f32 v132, v132, v140
    v_mfma_f32_16x16x32_bf16 v[52:55], v[204:207], a[188:191], v[52:55]
    v_mul_f32 v133, v133, v141
    v_mul_f32 v134, v134, v142
    v_mfma_f32_16x16x32_bf16 v[56:59], v[200:203], a[252:255], v[56:59]
    v_mul_f32 v135, v135, v143
    v_mfma_f32_16x16x32_bf16 v[60:63], v[204:207], a[252:255], v[60:63]
    s_waitcnt lgkmcnt(0)
    v_mfma_f32_16x16x32_bf16 v[64:67], v[176:179], a[0:3], 0
    s_add_u32 m0, s66, 0
    s_add_u32 s89, s97, 131072
    v_mfma_f32_16x16x32_bf16 v[68:71], v[180:183], a[0:3], 0
    buffer_load_dwordx4 v4, s[28:31], s89 offen offset:0 sc1 lds
    v_mfma_f32_16x16x32_bf16 v[72:75], v[176:179], a[64:67], 0
    buffer_load_dwordx4 v4, s[28:31], s89 offen offset:1024 sc1 lds
    s_waitcnt vmcnt(10)
    v_mfma_f32_16x16x32_bf16 v[76:79], v[180:183], a[64:67], 0
    ds_read_b64_tr_b16 v[192:193], v160 offset:16384
    ds_read_b64_tr_b16 v[194:195], v160 offset:17408
    v_mfma_f32_16x16x32_bf16 v[80:83], v[176:179], a[128:131], 0
    ds_read_b64_tr_b16 v[196:197], v160 offset:16392
    v_mfma_f32_16x16x32_bf16 v[84:87], v[180:183], a[128:131], 0
    ds_read_b64_tr_b16 v[198:199], v160 offset:17416
    v_mfma_f32_16x16x32_bf16 v[88:91], v[176:179], a[192:195], 0
    buffer_load_dwordx4 v4, s[28:31], s89 offen offset:2048 sc1 lds
    ds_read_b64_tr_b16 v[200:201], v16 offset:16384
    v_mfma_f32_16x16x32_bf16 v[92:95], v[180:183], a[192:195], 0
    ds_read_b64_tr_b16 v[202:203], v16 offset:17408
    v_cvt_pk_bf16_f32 v40, v40, v41
    v_mfma_f32_16x16x32_bf16 v[64:67], v[184:187], a[4:7], v[64:67]
    buffer_load_dwordx4 v4, s[28:31], s89 offen offset:3072 sc1 lds
    ds_read_b64_tr_b16 v[204:205], v16 offset:16392
    v_mfma_f32_16x16x32_bf16 v[68:71], v[188:191], a[4:7], v[68:71]
    ds_read_b64_tr_b16 v[206:207], v16 offset:17416
    v_cvt_pk_bf16_f32 v41, v42, v43
    v_mfma_f32_16x16x32_bf16 v[72:75], v[184:187], a[68:71], v[72:75]
    v_cvt_pk_bf16_f32 v42, v44, v45
    v_cvt_pk_bf16_f32 v43, v46, v47
    v_mfma_f32_16x16x32_bf16 v[76:79], v[188:191], a[68:71], v[76:79]
    ds_write_b128 v164, v[40:43] offset:0
    v_mfma_f32_16x16x32_bf16 v[80:83], v[184:187], a[132:135], v[80:83]
    s_add_u32 m0, s38, 65536
    s_add_u32 s89, s96, 0
    buffer_load_dwordx4 v4, s[28:31], s89 offen sc1 lds
    v_mfma_f32_16x16x32_bf16 v[84:87], v[188:191], a[132:135], v[84:87]
    v_cvt_pk_bf16_f32 v48, v48, v49
    v_cvt_pk_bf16_f32 v49, v50, v51
    v_cvt_pk_bf16_f32 v50, v52, v53
    v_mfma_f32_16x16x32_bf16 v[88:91], v[184:187], a[196:199], v[88:91]
    v_cvt_pk_bf16_f32 v51, v54, v55
    v_mfma_f32_16x16x32_bf16 v[92:95], v[188:191], a[196:199], v[92:95]
    ds_write_b128 v164, v[48:51] offset:1024
    s_waitcnt lgkmcnt(2)
    v_mfma_f32_16x16x32_bf16 v[64:67], v[192:195], a[8:11], v[64:67]
    s_add_u32 m0, s66, 16384
    s_add_u32 s89, s97, 135168
    v_mfma_f32_16x16x32_bf16 v[68:71], v[196:199], a[8:11], v[68:71]
    buffer_load_dwordx4 v4, s[28:31], s89 offen offset:0 sc1 lds
    v_cvt_pk_bf16_f32 v56, v56, v57
    v_mfma_f32_16x16x32_bf16 v[72:75], v[192:195], a[72:75], v[72:75]
    buffer_load_dwordx4 v4, s[28:31], s89 offen offset:1024 sc1 lds
    s_waitcnt vmcnt(11)
    v_mfma_f32_16x16x32_bf16 v[76:79], v[196:199], a[72:75], v[76:79]
    ds_read_b64_tr_b16 v[176:177], v160 offset:32768
    ds_read_b64_tr_b16 v[178:179], v160 offset:33792
    v_cvt_pk_bf16_f32 v57, v58, v59
    v_mfma_f32_16x16x32_bf16 v[80:83], v[192:195], a[136:139], v[80:83]
    ds_read_b64_tr_b16 v[180:181], v160 offset:32776
    ds_read_b64_tr_b16 v[182:183], v160 offset:33800
    v_mfma_f32_16x16x32_bf16 v[84:87], v[196:199], a[136:139], v[84:87]
    v_cvt_pk_bf16_f32 v58, v60, v61
    v_mfma_f32_16x16x32_bf16 v[88:91], v[192:195], a[200:203], v[88:91]
    buffer_load_dwordx4 v4, s[28:31], s89 offen offset:2048 sc1 lds
    ds_read_b64_tr_b16 v[184:185], v16 offset:32768
    v_mfma_f32_16x16x32_bf16 v[92:95], v[196:199], a[200:203], v[92:95]
    ds_read_b64_tr_b16 v[186:187], v16 offset:33792
    v_cvt_pk_bf16_f32 v59, v62, v63
    v_mfma_f32_16x16x32_bf16 v[64:67], v[200:203], a[12:15], v[64:67]
    buffer_load_dwordx4 v4, s[28:31], s89 offen offset:3072 sc1 lds
    ds_read_b64_tr_b16 v[188:189], v16 offset:32776
    v_mfma_f32_16x16x32_bf16 v[68:71], v[204:207], a[12:15], v[68:71]
    ds_read_b64_tr_b16 v[190:191], v16 offset:33800
    ds_write_b128 v164, v[56:59] offset:2048
    v_mfma_f32_16x16x32_bf16 v[72:75], v[200:203], a[76:79], v[72:75]
    v_add_f32 v32, v32, v18
    v_add_f32 v33, v33, v18
    v_mfma_f32_16x16x32_bf16 v[76:79], v[204:207], a[76:79], v[76:79]
    v_add_f32 v34, v34, v18
    v_mfma_f32_16x16x32_bf16 v[80:83], v[200:203], a[140:143], v[80:83]
    s_add_u32 m0, s38, 69632
    s_add_u32 s89, s96, 4096
    buffer_load_dwordx4 v4, s[28:31], s89 offen sc1 lds
    v_mfma_f32_16x16x32_bf16 v[84:87], v[204:207], a[140:143], v[84:87]
    v_add_f32 v35, v35, v18
    v_add_f32 v36, v36, v18
    v_add_f32 v37, v37, v18
    v_mfma_f32_16x16x32_bf16 v[88:91], v[200:203], a[204:207], v[88:91]
    v_add_f32 v38, v38, v18
    v_mfma_f32_16x16x32_bf16 v[92:95], v[204:207], a[204:207], v[92:95]
    v_add_f32 v39, v39, v18
    s_waitcnt lgkmcnt(1)
    v_mfma_f32_16x16x32_bf16 v[64:67], v[176:179], a[16:19], v[64:67]
    s_add_u32 m0, s66, 32768
    s_add_u32 s89, s97, 139264
    v_mfma_f32_16x16x32_bf16 v[68:71], v[180:183], a[16:19], v[68:71]
    buffer_load_dwordx4 v4, s[28:31], s89 offen offset:0 sc1 lds
    v_mfma_f32_16x16x32_bf16 v[72:75], v[176:179], a[80:83], v[72:75]
    buffer_load_dwordx4 v4, s[28:31], s89 offen offset:1024 sc1 lds
    s_waitcnt vmcnt(12)
    v_mfma_f32_16x16x32_bf16 v[76:79], v[180:183], a[80:83], v[76:79]
    ds_read_b64_tr_b16 v[192:193], v160 offset:49152
    ds_read_b64_tr_b16 v[194:195], v160 offset:50176
    v_mfma_f32_16x16x32_bf16 v[80:83], v[176:179], a[144:147], v[80:83]
    ds_read_b64_tr_b16 v[196:197], v160 offset:49160
    v_mfma_f32_16x16x32_bf16 v[84:87], v[180:183], a[144:147], v[84:87]
    ds_read_b64_tr_b16 v[198:199], v160 offset:50184
    v_mfma_f32_16x16x32_bf16 v[88:91], v[176:179], a[208:211], v[88:91]
    buffer_load_dwordx4 v4, s[28:31], s89 offen offset:2048 sc1 lds
    ds_read_b64_tr_b16 v[200:201], v16 offset:49152
    v_mfma_f32_16x16x32_bf16 v[92:95], v[180:183], a[208:211], v[92:95]
    ds_read_b64_tr_b16 v[202:203], v16 offset:50176
    v_mfma_f32_16x16x32_bf16 v[64:67], v[184:187], a[20:23], v[64:67]
    buffer_load_dwordx4 v4, s[28:31], s89 offen offset:3072 sc1 lds
    ds_read_b64_tr_b16 v[204:205], v16 offset:49160
    v_mfma_f32_16x16x32_bf16 v[68:71], v[188:191], a[20:23], v[68:71]
    ds_read_b64_tr_b16 v[206:207], v16 offset:50184
    v_mfma_f32_16x16x32_bf16 v[72:75], v[184:187], a[84:87], v[72:75]
    s_waitcnt lgkmcnt(8)
    v_mfma_f32_16x16x32_bf16 v[76:79], v[188:191], a[84:87], v[76:79]
    s_barrier
    v_mfma_f32_16x16x32_bf16 v[80:83], v[184:187], a[148:151], v[80:83]
    s_add_u32 m0, s38, 73728
    s_add_u32 s89, s96, 8192
    buffer_load_dwordx4 v4, s[28:31], s89 offen sc1 lds
    v_mfma_f32_16x16x32_bf16 v[84:87], v[188:191], a[148:151], v[84:87]
    ds_read_b128 v[44:47], v165 offset:0
    ds_read_b128 v[52:55], v166 offset:1024
    ds_read_b128 v[60:63], v167 offset:2048
    v_mfma_f32_16x16x32_bf16 v[88:91], v[184:187], a[212:215], v[88:91]
    v_mfma_f32_16x16x32_bf16 v[92:95], v[188:191], a[212:215], v[92:95]
    s_waitcnt lgkmcnt(3)
    v_mfma_f32_16x16x32_bf16 v[64:67], v[192:195], a[24:27], v[64:67]
    s_add_u32 m0, s66, 49152
    s_add_u32 s89, s97, 143360
    v_mfma_f32_16x16x32_bf16 v[68:71], v[196:199], a[24:27], v[68:71]
    buffer_load_dwordx4 v4, s[28:31], s89 offen offset:0 sc1 lds
    v_mfma_f32_16x16x32_bf16 v[72:75], v[192:195], a[88:91], v[72:75]
    buffer_load_dwordx4 v4, s[28:31], s89 offen offset:1024 sc1 lds
    s_waitcnt vmcnt(13)
    v_mfma_f32_16x16x32_bf16 v[76:79], v[196:199], a[88:91], v[76:79]
    ds_read_b64_tr_b16 v[176:177], v160 offset:0
    ds_read_b64_tr_b16 v[178:179], v160 offset:1024
    v_mfma_f32_16x16x32_bf16 v[80:83], v[192:195], a[152:155], v[80:83]
    ds_read_b64_tr_b16 v[180:181], v160 offset:8
    v_mfma_f32_16x16x32_bf16 v[84:87], v[196:199], a[152:155], v[84:87]
    ds_read_b64_tr_b16 v[182:183], v160 offset:1032
    v_mfma_f32_16x16x32_bf16 v[88:91], v[192:195], a[216:219], v[88:91]
    buffer_load_dwordx4 v4, s[28:31], s89 offen offset:2048 sc1 lds
    ds_read_b64_tr_b16 v[184:185], v16 offset:0
    v_mfma_f32_16x16x32_bf16 v[92:95], v[196:199], a[216:219], v[92:95]
    ds_read_b64_tr_b16 v[186:187], v16 offset:1024
    v_mfma_f32_16x16x32_bf16 v[64:67], v[200:203], a[28:31], v[64:67]
    buffer_load_dwordx4 v4, s[28:31], s89 offen offset:3072 sc1 lds
    ds_read_b64_tr_b16 v[188:189], v16 offset:8
    v_mfma_f32_16x16x32_bf16 v[68:71], v[204:207], a[28:31], v[68:71]
    ds_read_b64_tr_b16 v[190:191], v16 offset:1032
    v_mfma_f32_16x16x32_bf16 v[72:75], v[200:203], a[92:95], v[72:75]
    s_waitcnt lgkmcnt(10)
    v_lshlrev_b32 v40, 16, v44
    v_add_f32 v32, v32, v40
    v_mfma_f32_16x16x32_bf16 v[76:79], v[204:207], a[92:95], v[76:79]
    v_and_b32 v41, s39, v44
    v_mfma_f32_16x16x32_bf16 v[80:83], v[200:203], a[156:159], v[80:83]
    s_add_u32 m0, s38, 77824
    s_add_u32 s89, s96, 12288
    buffer_load_dwordx4 v4, s[28:31], s89 offen sc1 lds
    v_mfma_f32_16x16x32_bf16 v[84:87], v[204:207], a[156:159], v[84:87]
    v_add_f32 v33, v33, v41
    v_lshlrev_b32 v42, 16, v45
    v_add_f32 v34, v34, v42
    v_mfma_f32_16x16x32_bf16 v[88:91], v[200:203], a[220:223], v[88:91]
    v_and_b32 v43, s39, v45
    v_add_f32 v35, v35, v43
    v_mfma_f32_16x16x32_bf16 v[92:95], v[204:207], a[220:223], v[92:95]
    v_lshlrev_b32 v40, 16, v46
    s_waitcnt lgkmcnt(0)
    v_mfma_f32_16x16x32_bf16 v[64:67], v[176:179], a[32:35], v[64:67]
    s_add_u32 m0, s66, 0
    s_add_u32 s89, s87, 262144
    v_mfma_f32_16x16x32_bf16 v[68:71], v[180:183], a[32:35], v[68:71]
    buffer_load_dwordx4 v4, s[28:31], s89 offen offset:0 sc1 lds
    v_add_f32 v36, v36, v40
    v_mfma_f32_16x16x32_bf16 v[72:75], v[176:179], a[96:99], v[72:75]
    s_waitcnt vmcnt(12)
    v_mfma_f32_16x16x32_bf16 v[76:79], v[180:183], a[96:99], v[76:79]
    ds_read_b64_tr_b16 v[192:193], v160 offset:16384
    ds_read_b64_tr_b16 v[194:195], v160 offset:17408
    v_and_b32 v41, s39, v46
    v_mfma_f32_16x16x32_bf16 v[80:83], v[176:179], a[160:163], v[80:83]
    buffer_load_dwordx4 v4, s[28:31], s89 offen offset:1024 sc1 lds
    ds_read_b64_tr_b16 v[196:197], v160 offset:16392
    v_mfma_f32_16x16x32_bf16 v[84:87], v[180:183], a[160:163], v[84:87]
    ds_read_b64_tr_b16 v[198:199], v160 offset:17416
    v_add_f32 v37, v37, v41
    v_mfma_f32_16x16x32_bf16 v[88:91], v[176:179], a[224:227], v[88:91]
    ds_read_b64_tr_b16 v[200:201], v16 offset:16384
    ds_read_b64_tr_b16 v[202:203], v16 offset:17408
    v_mfma_f32_16x16x32_bf16 v[92:95], v[180:183], a[224:227], v[92:95]
    v_lshlrev_b32 v42, 16, v47
    v_mfma_f32_16x16x32_bf16 v[64:67], v[184:187], a[36:39], v[64:67]
    buffer_load_dwordx4 v4, s[28:31], s89 offen offset:2048 sc1 lds
    ds_read_b64_tr_b16 v[204:205], v16 offset:16392
    v_mfma_f32_16x16x32_bf16 v[68:71], v[188:191], a[36:39], v[68:71]
    ds_read_b64_tr_b16 v[206:207], v16 offset:17416
    v_add_f32 v38, v38, v42
    v_mfma_f32_16x16x32_bf16 v[72:75], v[184:187], a[100:103], v[72:75]
    v_and_b32 v43, s39, v47
    v_add_f32 v39, v39, v43
    v_mfma_f32_16x16x32_bf16 v[76:79], v[188:191], a[100:103], v[76:79]
    v_lshlrev_b32 v40, 16, v52
    v_mfma_f32_16x16x32_bf16 v[80:83], v[184:187], a[164:167], v[80:83]
    s_add_u32 m0, s38, 81920
    s_add_u32 s89, s96, 16384
    buffer_load_dwordx4 v4, s[28:31], s89 offen sc1 lds
    v_mfma_f32_16x16x32_bf16 v[84:87], v[188:191], a[164:167], v[84:87]
    v_add_f32 v32, v32, v40
    v_and_b32 v41, s39, v52
    v_add_f32 v33, v33, v41
    v_mfma_f32_16x16x32_bf16 v[88:91], v[184:187], a[228:231], v[88:91]
    v_lshlrev_b32 v42, 16, v53
    v_add_f32 v34, v34, v42
    v_mfma_f32_16x16x32_bf16 v[92:95], v[188:191], a[228:231], v[92:95]
    v_and_b32 v43, s39, v53
    s_waitcnt lgkmcnt(0)
    v_mfma_f32_16x16x32_bf16 v[64:67], v[192:195], a[40:43], v[64:67]
    s_add_u32 m0, s66, 16384
    s_add_u32 s89, s87, 265216
    v_mfma_f32_16x16x32_bf16 v[68:71], v[196:199], a[40:43], v[68:71]
    buffer_load_dwordx4 v4, s[28:31], s89 offen offset:0 sc1 lds
    v_add_f32 v35, v35, v43
    v_mfma_f32_16x16x32_bf16 v[72:75], v[192:195], a[104:107], v[72:75]
    s_waitcnt vmcnt(11)
    v_mfma_f32_16x16x32_bf16 v[76:79], v[196:199], a[104:107], v[76:79]
    ds_read_b64_tr_b16 v[176:177], v160 offset:32768
    ds_read_b64_tr_b16 v[178:179], v160 offset:33792
    v_lshlrev_b32 v40, 16, v54
    v_mfma_f32_16x16x32_bf16 v[80:83], v[192:195], a[168:171], v[80:83]
    buffer_load_dwordx4 v4, s[28:31], s89 offen offset:1024 sc1 lds
    ds_read_b64_tr_b16 v[180:181], v160 offset:32776
    v_mfma_f32_16x16x32_bf16 v[84:87], v[196:199], a[168:171], v[84:87]
    ds_read_b64_tr_b16 v[182:183], v160 offset:33800
    v_add_f32 v36, v36, v40
    v_mfma_f32_16x16x32_bf16 v[88:91], v[192:195], a[232:235], v[88:91]
    ds_read_b64_tr_b16 v[184:185], v16 offset:32768
    ds_read_b64_tr_b16 v[186:187], v16 offset:33792
    v_mfma_f32_16x16x32_bf16 v[92:95], v[196:199], a[232:235], v[92:95]
    v_and_b32 v41, s39, v54
    v_mfma_f32_16x16x32_bf16 v[64:67], v[200:203], a[44:47], v[64:67]
    buffer_load_dwordx4 v4, s[28:31], s89 offen offset:2048 sc1 lds
    ds_read_b64_tr_b16 v[188:189], v16 offset:32776
    v_mfma_f32_16x16x32_bf16 v[68:71], v[204:207], a[44:47], v[68:71]
    ds_read_b64_tr_b16 v[190:191], v16 offset:33800
    v_add_f32 v37, v37, v41
    v_mfma_f32_16x16x32_bf16 v[72:75], v[200:203], a[108:111], v[72:75]
    v_lshlrev_b32 v42, 16, v55
    v_add_f32 v38, v38, v42
    v_mfma_f32_16x16x32_bf16 v[76:79], v[204:207], a[108:111], v[76:79]
    v_and_b32 v43, s39, v55
    v_mfma_f32_16x16x32_bf16 v[80:83], v[200:203], a[172:175], v[80:83]
    s_add_u32 m0, s38, 86016
    s_add_u32 s89, s96, 20480
    buffer_load_dwordx4 v4, s[28:31], s89 offen sc1 lds
    v_mfma_f32_16x16x32_bf16 v[84:87], v[204:207], a[172:175], v[84:87]
    v_add_f32 v39, v39, v43
    v_lshlrev_b32 v40, 16, v60
    v_add_f32 v32, v32, v40
    v_mfma_f32_16x16x32_bf16 v[88:91], v[200:203], a[236:239], v[88:91]
    v_and_b32 v41, s39, v60
    v_add_f32 v33, v33, v41
    v_mfma_f32_16x16x32_bf16 v[92:95], v[204:207], a[236:239], v[92:95]
    v_lshlrev_b32 v42, 16, v61
    s_waitcnt lgkmcnt(0)
    v_mfma_f32_16x16x32_bf16 v[64:67], v[176:179], a[48:51], v[64:67]
    s_add_u32 m0, s66, 32768
    s_add_u32 s89, s87, 268288
    v_mfma_f32_16x16x32_bf16 v[68:71], v[180:183], a[48:51], v[68:71]
    buffer_load_dwordx4 v4, s[28:31], s89 offen offset:0 sc1 lds
    v_add_f32 v34, v34, v42
    v_mfma_f32_16x16x32_bf16 v[72:75], v[176:179], a[112:115], v[72:75]
    s_waitcnt vmcnt(10)
    v_mfma_f32_16x16x32_bf16 v[76:79], v[180:183], a[112:115], v[76:79]
    ds_read_b64_tr_b16 v[192:193], v160 offset:49152
    ds_read_b64_tr_b16 v[194:195], v160 offset:50176
    v_and_b32 v43, s39, v61
    v_mfma_f32_16x16x32_bf16 v[80:83], v[176:179], a[176:179], v[80:83]
    buffer_load_dwordx4 v4, s[28:31], s89 offen offset:1024 sc1 lds
    ds_read_b64_tr_b16 v[196:197], v160 offset:49160
    v_mfma_f32_16x16x32_bf16 v[84:87], v[180:183], a[176:179], v[84:87]
    ds_read_b64_tr_b16 v[198:199], v160 offset:50184
    v_add_f32 v35, v35, v43
    v_mfma_f32_16x16x32_bf16 v[88:91], v[176:179], a[240:243], v[88:91]
    ds_read_b64_tr_b16 v[200:201], v16 offset:49152
    ds_read_b64_tr_b16 v[202:203], v16 offset:50176
    v_mfma_f32_16x16x32_bf16 v[92:95], v[180:183], a[240:243], v[92:95]
    v_lshlrev_b32 v40, 16, v62
    v_mfma_f32_16x16x32_bf16 v[64:67], v[184:187], a[52:55], v[64:67]
    buffer_load_dwordx4 v4, s[28:31], s89 offen offset:2048 sc1 lds
    ds_read_b64_tr_b16 v[204:205], v16 offset:49160
    v_mfma_f32_16x16x32_bf16 v[68:71], v[188:191], a[52:55], v[68:71]
    ds_read_b64_tr_b16 v[206:207], v16 offset:50184
    v_add_f32 v36, v36, v40
    v_mfma_f32_16x16x32_bf16 v[72:75], v[184:187], a[116:119], v[72:75]
    v_and_b32 v41, s39, v62
    v_add_f32 v37, v37, v41
    v_mfma_f32_16x16x32_bf16 v[76:79], v[188:191], a[116:119], v[76:79]
    v_lshlrev_b32 v42, 16, v63
    v_mfma_f32_16x16x32_bf16 v[80:83], v[184:187], a[180:183], v[80:83]
    s_add_u32 m0, s38, 90112
    s_add_u32 s89, s96, 24576
    buffer_load_dwordx4 v4, s[28:31], s89 offen sc1 lds
    v_mfma_f32_16x16x32_bf16 v[84:87], v[188:191], a[180:183], v[84:87]
    v_add_f32 v38, v38, v42
    v_and_b32 v43, s39, v63
    v_add_f32 v39, v39, v43
    v_mfma_f32_16x16x32_bf16 v[88:91], v[184:187], a[244:247], v[88:91]
    v_mul_f32 v32, v32, v96
    v_mul_f32 v33, v33, v97
    v_mfma_f32_16x16x32_bf16 v[92:95], v[188:191], a[244:247], v[92:95]
    v_mul_f32 v34, v34, v98
    s_waitcnt lgkmcnt(0)
    v_mfma_f32_16x16x32_bf16 v[64:67], v[192:195], a[56:59], v[64:67]
    s_add_u32 m0, s66, 49152
    s_add_u32 s89, s87, 271360
    v_mfma_f32_16x16x32_bf16 v[68:71], v[196:199], a[56:59], v[68:71]
    buffer_load_dwordx4 v4, s[28:31], s89 offen offset:0 sc1 lds
    v_mul_f32 v35, v35, v99
    v_mfma_f32_16x16x32_bf16 v[72:75], v[192:195], a[120:123], v[72:75]
    s_waitcnt vmcnt(10)
    v_mfma_f32_16x16x32_bf16 v[76:79], v[196:199], a[120:123], v[76:79]
    ds_read_b64_tr_b16 v[176:177], v28 offset:0
    ds_read_b64_tr_b16 v[178:179], v28 offset:768
    v_mul_f32 v36, v36, v100
    v_mfma_f32_16x16x32_bf16 v[80:83], v[192:195], a[184:187], v[80:83]
    buffer_load_dwordx4 v4, s[28:31], s89 offen offset:1024 sc1 lds
    ds_read_b64_tr_b16 v[180:181], v28 offset:8
    v_mfma_f32_16x16x32_bf16 v[84:87], v[196:199], a[184:187], v[84:87]
    ds_read_b64_tr_b16 v[182:183], v28 offset:776
    v_mul_f32 v37, v37, v101
    v_mfma_f32_16x16x32_bf16 v[88:91], v[192:195], a[248:251], v[88:91]
    ds_read_b64_tr_b16 v[184:185], v29 offset:0
    ds_read_b64_tr_b16 v[186:187], v29 offset:768
    v_mfma_f32_16x16x32_bf16 v[92:95], v[196:199], a[248:251], v[92:95]
    v_mul_f32 v38, v38, v102
    v_mfma_f32_16x16x32_bf16 v[64:67], v[200:203], a[60:63], v[64:67]
    buffer_load_dwordx4 v4, s[28:31], s89 offen offset:2048 sc1 lds
    ds_read_b64_tr_b16 v[188:189], v29 offset:8
    v_mfma_f32_16x16x32_bf16 v[68:71], v[204:207], a[60:63], v[68:71]
    ds_read_b64_tr_b16 v[190:191], v29 offset:776
    v_mul_f32 v39, v39, v103
    v_mfma_f32_16x16x32_bf16 v[72:75], v[200:203], a[124:127], v[72:75]
    v_cvt_pk_bf16_f32 v240, v32, v33
    v_cvt_pk_bf16_f32 v241, v34, v35
    v_mfma_f32_16x16x32_bf16 v[76:79], v[204:207], a[124:127], v[76:79]
    v_cvt_pk_bf16_f32 v242, v36, v37
    v_mfma_f32_16x16x32_bf16 v[80:83], v[200:203], a[188:191], v[80:83]
    s_add_u32 m0, s38, 94208
    s_add_u32 s89, s96, 28672
    buffer_load_dwordx4 v4, s[28:31], s89 offen sc1 lds
    v_mfma_f32_16x16x32_bf16 v[84:87], v[204:207], a[188:191], v[84:87]
    v_cvt_pk_bf16_f32 v243, v38, v39
    v_or_b32 v240, 1, v240
    v_add_u32 v164, s66, v4
    v_mfma_f32_16x16x32_bf16 v[88:91], v[200:203], a[252:255], v[88:91]
    v_xor_b32 v165, 4096, v164
    v_xor_b32 v166, 8192, v164
    v_mfma_f32_16x16x32_bf16 v[92:95], v[204:207], a[252:255], v[92:95]
    v_xor_b32 v167, 12288, v164
    buffer_store_dwordx4 v[240:243], v161, s[28:31], s83 offen sc1
    s_waitcnt lgkmcnt(0)
    v_mfma_f32_16x16x32_bf16 v[208:211], v[176:179], a[0:3], 0
    s_add_u32 m0, s66, 0
    s_add_u32 s89, s97, 262144
    v_mfma_f32_16x16x32_bf16 v[212:215], v[180:183], a[0:3], 0
    buffer_load_dwordx4 v4, s[28:31], s89 offen offset:0 sc1 lds
    v_mfma_f32_16x16x32_bf16 v[216:219], v[176:179], a[64:67], 0
    s_waitcnt vmcnt(11)
    v_mfma_f32_16x16x32_bf16 v[220:223], v[180:183], a[64:67], 0
    ds_read_b64_tr_b16 v[192:193], v28 offset:16384
    ds_read_b64_tr_b16 v[194:195], v28 offset:17152
    v_mfma_f32_16x16x32_bf16 v[224:227], v[176:179], a[128:131], 0
    buffer_load_dwordx4 v4, s[28:31], s89 offen offset:1024 sc1 lds
    ds_read_b64_tr_b16 v[196:197], v28 offset:16392
    v_mfma_f32_16x16x32_bf16 v[228:231], v[180:183], a[128:131], 0
    ds_read_b64_tr_b16 v[198:199], v28 offset:17160
    v_mfma_f32_16x16x32_bf16 v[232:235], v[176:179], a[192:195], 0
    ds_read_b64_tr_b16 v[200:201], v29 offset:16384
    ds_read_b64_tr_b16 v[202:203], v29 offset:17152
    v_mfma_f32_16x16x32_bf16 v[236:239], v[180:183], a[192:195], 0
    v_cvt_pk_bf16_f32 v72, v72, v73
    v_mfma_f32_16x16x32_bf16 v[208:211], v[184:187], a[4:7], v[208:211]
    buffer_load_dwordx4 v4, s[28:31], s89 offen offset:2048 sc1 lds
    ds_read_b64_tr_b16 v[204:205], v29 offset:16392
    v_mfma_f32_16x16x32_bf16 v[212:215], v[188:191], a[4:7], v[212:215]
    ds_read_b64_tr_b16 v[206:207], v29 offset:17160
    v_cvt_pk_bf16_f32 v73, v74, v75
    v_mfma_f32_16x16x32_bf16 v[216:219], v[184:187], a[68:71], v[216:219]
    v_cvt_pk_bf16_f32 v74, v76, v77
    v_cvt_pk_bf16_f32 v75, v78, v79
    v_mfma_f32_16x16x32_bf16 v[220:223], v[188:191], a[68:71], v[220:223]
    ds_write_b128 v164, v[72:75] offset:3072
    v_mfma_f32_16x16x32_bf16 v[224:227], v[184:187], a[132:135], v[224:227]
    s_add_u32 m0, s38, 98304
    s_add_u32 s89, s96, 32768
    buffer_load_dwordx4 v4, s[28:31], s89 offen sc1 lds
    v_mfma_f32_16x16x32_bf16 v[228:231], v[188:191], a[132:135], v[228:231]
    v_cvt_pk_bf16_f32 v80, v80, v81
    v_cvt_pk_bf16_f32 v81, v82, v83
    v_cvt_pk_bf16_f32 v82, v84, v85
    v_mfma_f32_16x16x32_bf16 v[232:235], v[184:187], a[196:199], v[232:235]
    v_cvt_pk_bf16_f32 v83, v86, v87
    v_mfma_f32_16x16x32_bf16 v[236:239], v[188:191], a[196:199], v[236:239]
    ds_write_b128 v164, v[80:83] offset:19456
    s_waitcnt lgkmcnt(2)
    v_mfma_f32_16x16x32_bf16 v[208:211], v[192:195], a[8:11], v[208:211]
    s_add_u32 m0, s66, 16384
    s_add_u32 s89, s97, 265216
    v_mfma_f32_16x16x32_bf16 v[212:215], v[196:199], a[8:11], v[212:215]
    buffer_load_dwordx4 v4, s[28:31], s89 offen offset:0 sc1 lds
    v_cvt_pk_bf16_f32 v88, v88, v89
    v_mfma_f32_16x16x32_bf16 v[216:219], v[192:195], a[72:75], v[216:219]
    s_waitcnt vmcnt(11)
    v_mfma_f32_16x16x32_bf16 v[220:223], v[196:199], a[72:75], v[220:223]
    ds_read_b64_tr_b16 v[176:177], v28 offset:32768
    ds_read_b64_tr_b16 v[178:179], v28 offset:33536
    v_cvt_pk_bf16_f32 v89, v90, v91
    v_mfma_f32_16x16x32_bf16 v[224:227], v[192:195], a[136:139], v[224:227]
    buffer_load_dwordx4 v4, s[28:31], s89 offen offset:1024 sc1 lds
    ds_read_b64_tr_b16 v[180:181], v28 offset:32776
    v_mfma_f32_16x16x32_bf16 v[228:231], v[196:199], a[136:139], v[228:231]
    ds_read_b64_tr_b16 v[182:183], v28 offset:33544
    v_cvt_pk_bf16_f32 v90, v92, v93
    v_mfma_f32_16x16x32_bf16 v[232:235], v[192:195], a[200:203], v[232:235]
    ds_read_b64_tr_b16 v[184:185], v29 offset:32768
    ds_read_b64_tr_b16 v[186:187], v29 offset:33536
    v_mfma_f32_16x16x32_bf16 v[236:239], v[196:199], a[200:203], v[236:239]
    v_cvt_pk_bf16_f32 v91, v94, v95
    v_mfma_f32_16x16x32_bf16 v[208:211], v[200:203], a[12:15], v[208:211]
    buffer_load_dwordx4 v4, s[28:31], s89 offen offset:2048 sc1 lds
    ds_read_b64_tr_b16 v[188:189], v29 offset:32776
    v_mfma_f32_16x16x32_bf16 v[212:215], v[204:207], a[12:15], v[212:215]
    ds_read_b64_tr_b16 v[190:191], v29 offset:33544
    ds_write_b128 v164, v[88:91] offset:35840
    v_mfma_f32_16x16x32_bf16 v[216:219], v[200:203], a[76:79], v[216:219]
    v_add_f32 v64, v64, v18
    v_add_f32 v65, v65, v18
    v_mfma_f32_16x16x32_bf16 v[220:223], v[204:207], a[76:79], v[220:223]
    v_add_f32 v66, v66, v18
    v_mfma_f32_16x16x32_bf16 v[224:227], v[200:203], a[140:143], v[224:227]
    s_add_u32 m0, s38, 102400
    s_add_u32 s89, s96, 36864
    buffer_load_dwordx4 v4, s[28:31], s89 offen sc1 lds
    v_mfma_f32_16x16x32_bf16 v[228:231], v[204:207], a[140:143], v[228:231]
    v_add_f32 v67, v67, v18
    v_add_f32 v68, v68, v18
    v_add_f32 v69, v69, v18
    v_mfma_f32_16x16x32_bf16 v[232:235], v[200:203], a[204:207], v[232:235]
    v_add_f32 v70, v70, v18
    v_mfma_f32_16x16x32_bf16 v[236:239], v[204:207], a[204:207], v[236:239]
    v_add_f32 v71, v71, v18
    s_waitcnt lgkmcnt(1)
    v_mfma_f32_16x16x32_bf16 v[208:211], v[176:179], a[16:19], v[208:211]
    s_add_u32 m0, s66, 32768
    s_add_u32 s89, s97, 268288
    v_mfma_f32_16x16x32_bf16 v[212:215], v[180:183], a[16:19], v[212:215]
    buffer_load_dwordx4 v4, s[28:31], s89 offen offset:0 sc1 lds
    v_mfma_f32_16x16x32_bf16 v[216:219], v[176:179], a[80:83], v[216:219]
    s_waitcnt vmcnt(11)
    v_mfma_f32_16x16x32_bf16 v[220:223], v[180:183], a[80:83], v[220:223]
    ds_read_b64_tr_b16 v[192:193], v28 offset:49152
    ds_read_b64_tr_b16 v[194:195], v28 offset:49920
    v_mfma_f32_16x16x32_bf16 v[224:227], v[176:179], a[144:147], v[224:227]
    buffer_load_dwordx4 v4, s[28:31], s89 offen offset:1024 sc1 lds
    ds_read_b64_tr_b16 v[196:197], v28 offset:49160
    v_mfma_f32_16x16x32_bf16 v[228:231], v[180:183], a[144:147], v[228:231]
    ds_read_b64_tr_b16 v[198:199], v28 offset:49928
    v_mfma_f32_16x16x32_bf16 v[232:235], v[176:179], a[208:211], v[232:235]
    ds_read_b64_tr_b16 v[200:201], v29 offset:49152
    v_mfma_f32_16x16x32_bf16 v[236:239], v[180:183], a[208:211], v[236:239]
    ds_read_b64_tr_b16 v[202:203], v29 offset:49920
    v_mfma_f32_16x16x32_bf16 v[208:211], v[184:187], a[20:23], v[208:211]
    buffer_load_dwordx4 v4, s[28:31], s89 offen offset:2048 sc1 lds
    ds_read_b64_tr_b16 v[204:205], v29 offset:49160
    v_mfma_f32_16x16x32_bf16 v[212:215], v[188:191], a[20:23], v[212:215]
    ds_read_b64_tr_b16 v[206:207], v29 offset:49928
    v_mfma_f32_16x16x32_bf16 v[216:219], v[184:187], a[84:87], v[216:219]
    s_waitcnt lgkmcnt(8)
    v_mfma_f32_16x16x32_bf16 v[220:223], v[188:191], a[84:87], v[220:223]
    s_barrier
    v_mfma_f32_16x16x32_bf16 v[224:227], v[184:187], a[148:151], v[224:227]
    s_add_u32 m0, s38, 106496
    s_add_u32 s89, s96, 40960
    buffer_load_dwordx4 v4, s[28:31], s89 offen sc1 lds
    v_mfma_f32_16x16x32_bf16 v[228:231], v[188:191], a[148:151], v[228:231]
    ds_read_b128 v[76:79], v165 offset:3072
    ds_read_b128 v[84:87], v166 offset:19456
    ds_read_b128 v[92:95], v167 offset:35840
    v_mfma_f32_16x16x32_bf16 v[232:235], v[184:187], a[212:215], v[232:235]
    v_mfma_f32_16x16x32_bf16 v[236:239], v[188:191], a[212:215], v[236:239]
    s_waitcnt lgkmcnt(3)
    v_mfma_f32_16x16x32_bf16 v[208:211], v[192:195], a[24:27], v[208:211]
    s_add_u32 m0, s66, 49152
    s_add_u32 s89, s97, 271360
    v_mfma_f32_16x16x32_bf16 v[212:215], v[196:199], a[24:27], v[212:215]
    buffer_load_dwordx4 v4, s[28:31], s89 offen offset:0 sc1 lds
    v_mfma_f32_16x16x32_bf16 v[216:219], v[192:195], a[88:91], v[216:219]
    s_waitcnt vmcnt(10)
    v_mfma_f32_16x16x32_bf16 v[220:223], v[196:199], a[88:91], v[220:223]
    ds_read_b64_tr_b16 v[176:177], v28 offset:0
    ds_read_b64_tr_b16 v[178:179], v28 offset:768
    v_mfma_f32_16x16x32_bf16 v[224:227], v[192:195], a[152:155], v[224:227]
    buffer_load_dwordx4 v4, s[28:31], s89 offen offset:1024 sc1 lds
    ds_read_b64_tr_b16 v[180:181], v28 offset:8
    v_mfma_f32_16x16x32_bf16 v[228:231], v[196:199], a[152:155], v[228:231]
    ds_read_b64_tr_b16 v[182:183], v28 offset:776
    v_mfma_f32_16x16x32_bf16 v[232:235], v[192:195], a[216:219], v[232:235]
    ds_read_b64_tr_b16 v[184:185], v29 offset:0
    v_mfma_f32_16x16x32_bf16 v[236:239], v[196:199], a[216:219], v[236:239]
    ds_read_b64_tr_b16 v[186:187], v29 offset:768
    v_mfma_f32_16x16x32_bf16 v[208:211], v[200:203], a[28:31], v[208:211]
    buffer_load_dwordx4 v4, s[28:31], s89 offen offset:2048 sc1 lds
    ds_read_b64_tr_b16 v[188:189], v29 offset:8
    v_mfma_f32_16x16x32_bf16 v[212:215], v[204:207], a[28:31], v[212:215]
    ds_read_b64_tr_b16 v[190:191], v29 offset:776
    v_mfma_f32_16x16x32_bf16 v[216:219], v[200:203], a[92:95], v[216:219]
    s_waitcnt lgkmcnt(10)
    v_lshlrev_b32 v72, 16, v76
    v_add_f32 v64, v64, v72
    v_mfma_f32_16x16x32_bf16 v[220:223], v[204:207], a[92:95], v[220:223]
    v_and_b32 v73, s39, v76
    v_mfma_f32_16x16x32_bf16 v[224:227], v[200:203], a[156:159], v[224:227]
    s_add_u32 m0, s38, 110592
    s_add_u32 s89, s96, 45056
    buffer_load_dwordx4 v4, s[28:31], s89 offen sc1 lds
    v_mfma_f32_16x16x32_bf16 v[228:231], v[204:207], a[156:159], v[228:231]
    v_add_f32 v65, v65, v73
    v_lshlrev_b32 v74, 16, v77
    v_add_f32 v66, v66, v74
    v_mfma_f32_16x16x32_bf16 v[232:235], v[200:203], a[220:223], v[232:235]
    v_and_b32 v75, s39, v77
    v_add_f32 v67, v67, v75
    v_mfma_f32_16x16x32_bf16 v[236:239], v[204:207], a[220:223], v[236:239]
    v_lshlrev_b32 v72, 16, v78
    s_waitcnt lgkmcnt(0)
    v_mfma_f32_16x16x32_bf16 v[208:211], v[176:179], a[32:35], v[208:211]
    s_add_u32 m0, s38, 114688
    s_add_u32 s89, s96, 49152
    v_mfma_f32_16x16x32_bf16 v[212:215], v[180:183], a[32:35], v[212:215]
    buffer_load_dwordx4 v4, s[28:31], s89 offen sc1 lds
    v_add_f32 v68, v68, v72
    v_mfma_f32_16x16x32_bf16 v[216:219], v[176:179], a[96:99], v[216:219]
    s_waitcnt vmcnt(10)
    v_mfma_f32_16x16x32_bf16 v[220:223], v[180:183], a[96:99], v[220:223]
    ds_read_b64_tr_b16 v[192:193], v28 offset:16384
    ds_read_b64_tr_b16 v[194:195], v28 offset:17152
    v_and_b32 v73, s39, v78
    v_mfma_f32_16x16x32_bf16 v[224:227], v[176:179], a[160:163], v[224:227]
    s_add_u32 m0, s38, 118784
    s_add_u32 s89, s96, 53248
    buffer_load_dwordx4 v4, s[28:31], s89 offen sc1 lds
    v_mfma_f32_16x16x32_bf16 v[228:231], v[180:183], a[160:163], v[228:231]
    ds_read_b64_tr_b16 v[196:197], v28 offset:16392
    ds_read_b64_tr_b16 v[198:199], v28 offset:17160
    v_add_f32 v69, v69, v73
    v_mfma_f32_16x16x32_bf16 v[232:235], v[176:179], a[224:227], v[232:235]
    ds_read_b64_tr_b16 v[200:201], v29 offset:16384
    ds_read_b64_tr_b16 v[202:203], v29 offset:17152
    v_mfma_f32_16x16x32_bf16 v[236:239], v[180:183], a[224:227], v[236:239]
    v_lshlrev_b32 v74, 16, v79
    v_mfma_f32_16x16x32_bf16 v[208:211], v[184:187], a[36:39], v[208:211]
    s_add_u32 m0, s38, 122880
    s_add_u32 s89, s96, 57344
    buffer_load_dwordx4 v4, s[28:31], s89 offen sc1 lds
    v_mfma_f32_16x16x32_bf16 v[212:215], v[188:191], a[36:39], v[212:215]
    ds_read_b64_tr_b16 v[204:205], v29 offset:16392
    ds_read_b64_tr_b16 v[206:207], v29 offset:17160
    v_add_f32 v70, v70, v74
    v_mfma_f32_16x16x32_bf16 v[216:219], v[184:187], a[100:103], v[216:219]
    v_and_b32 v75, s39, v79
    v_add_f32 v71, v71, v75
    v_mfma_f32_16x16x32_bf16 v[220:223], v[188:191], a[100:103], v[220:223]
    v_lshlrev_b32 v72, 16, v84
    v_mfma_f32_16x16x32_bf16 v[224:227], v[184:187], a[164:167], v[224:227]
    v_add_f32 v64, v64, v72
    v_and_b32 v73, s39, v84
    v_mfma_f32_16x16x32_bf16 v[228:231], v[188:191], a[164:167], v[228:231]
    v_add_f32 v65, v65, v73
    v_mfma_f32_16x16x32_bf16 v[232:235], v[184:187], a[228:231], v[232:235]
    v_lshlrev_b32 v74, 16, v85
    v_add_f32 v66, v66, v74
    v_mfma_f32_16x16x32_bf16 v[236:239], v[188:191], a[228:231], v[236:239]
    v_and_b32 v75, s39, v85
    s_waitcnt lgkmcnt(0)
    v_mfma_f32_16x16x32_bf16 v[208:211], v[192:195], a[40:43], v[208:211]
    s_add_u32 m0, s38, 126976
    s_add_u32 s89, s96, 61440
    v_mfma_f32_16x16x32_bf16 v[212:215], v[196:199], a[40:43], v[212:215]
    buffer_load_dwordx4 v4, s[28:31], s89 offen sc1 lds
    v_add_f32 v67, v67, v75
    v_mfma_f32_16x16x32_bf16 v[216:219], v[192:195], a[104:107], v[216:219]
    s_waitcnt vmcnt(9)
    v_mfma_f32_16x16x32_bf16 v[220:223], v[196:199], a[104:107], v[220:223]
    ds_read_b64_tr_b16 v[176:177], v28 offset:32768
    ds_read_b64_tr_b16 v[178:179], v28 offset:33536
    v_lshlrev_b32 v72, 16, v86
    v_mfma_f32_16x16x32_bf16 v[224:227], v[192:195], a[168:171], v[224:227]
    s_add_u32 m0, s38, 131072
    s_add_u32 s89, s96, 65536
    buffer_load_dwordx4 v4, s[28:31], s89 offen sc1 lds
    v_mfma_f32_16x16x32_bf16 v[228:231], v[196:199], a[168:171], v[228:231]
    ds_read_b64_tr_b16 v[180:181], v28 offset:32776
    ds_read_b64_tr_b16 v[182:183], v28 offset:33544
    v_add_f32 v68, v68, v72
    v_mfma_f32_16x16x32_bf16 v[232:235], v[192:195], a[232:235], v[232:235]
    ds_read_b64_tr_b16 v[184:185], v29 offset:32768
    ds_read_b64_tr_b16 v[186:187], v29 offset:33536
    v_mfma_f32_16x16x32_bf16 v[236:239], v[196:199], a[232:235], v[236:239]
    v_and_b32 v73, s39, v86
    v_mfma_f32_16x16x32_bf16 v[208:211], v[200:203], a[44:47], v[208:211]
    s_add_u32 m0, s38, 135168
    s_add_u32 s89, s96, 69632
    buffer_load_dwordx4 v4, s[28:31], s89 offen sc1 lds
    v_mfma_f32_16x16x32_bf16 v[212:215], v[204:207], a[44:47], v[212:215]
    ds_read_b64_tr_b16 v[188:189], v29 offset:32776
    ds_read_b64_tr_b16 v[190:191], v29 offset:33544
    v_add_f32 v69, v69, v73
    v_mfma_f32_16x16x32_bf16 v[216:219], v[200:203], a[108:111], v[216:219]
    v_lshlrev_b32 v74, 16, v87
    v_add_f32 v70, v70, v74
    v_mfma_f32_16x16x32_bf16 v[220:223], v[204:207], a[108:111], v[220:223]
    v_and_b32 v75, s39, v87
    v_mfma_f32_16x16x32_bf16 v[224:227], v[200:203], a[172:175], v[224:227]
    v_add_f32 v71, v71, v75
    v_lshlrev_b32 v72, 16, v92
    v_mfma_f32_16x16x32_bf16 v[228:231], v[204:207], a[172:175], v[228:231]
    v_add_f32 v64, v64, v72
    v_mfma_f32_16x16x32_bf16 v[232:235], v[200:203], a[236:239], v[232:235]
    v_and_b32 v73, s39, v92
    v_add_f32 v65, v65, v73
    v_mfma_f32_16x16x32_bf16 v[236:239], v[204:207], a[236:239], v[236:239]
    v_lshlrev_b32 v74, 16, v93
    s_waitcnt lgkmcnt(0)
    v_mfma_f32_16x16x32_bf16 v[208:211], v[176:179], a[48:51], v[208:211]
    s_add_u32 m0, s38, 139264
    s_add_u32 s89, s96, 73728
    v_mfma_f32_16x16x32_bf16 v[212:215], v[180:183], a[48:51], v[212:215]
    buffer_load_dwordx4 v4, s[28:31], s89 offen sc1 lds
    v_add_f32 v66, v66, v74
    v_mfma_f32_16x16x32_bf16 v[216:219], v[176:179], a[112:115], v[216:219]
    s_waitcnt vmcnt(8)
    v_mfma_f32_16x16x32_bf16 v[220:223], v[180:183], a[112:115], v[220:223]
    ds_read_b64_tr_b16 v[192:193], v28 offset:49152
    ds_read_b64_tr_b16 v[194:195], v28 offset:49920
    v_and_b32 v75, s39, v93
    v_mfma_f32_16x16x32_bf16 v[224:227], v[176:179], a[176:179], v[224:227]
    s_add_u32 m0, s38, 143360
    s_add_u32 s89, s96, 77824
    buffer_load_dwordx4 v4, s[28:31], s89 offen sc1 lds
    v_mfma_f32_16x16x32_bf16 v[228:231], v[180:183], a[176:179], v[228:231]
    ds_read_b64_tr_b16 v[196:197], v28 offset:49160
    ds_read_b64_tr_b16 v[198:199], v28 offset:49928
    v_add_f32 v67, v67, v75
    v_mfma_f32_16x16x32_bf16 v[232:235], v[176:179], a[240:243], v[232:235]
    ds_read_b64_tr_b16 v[200:201], v29 offset:49152
    ds_read_b64_tr_b16 v[202:203], v29 offset:49920
    v_mfma_f32_16x16x32_bf16 v[236:239], v[180:183], a[240:243], v[236:239]
    v_lshlrev_b32 v72, 16, v94
    v_mfma_f32_16x16x32_bf16 v[208:211], v[184:187], a[52:55], v[208:211]
    s_add_u32 m0, s38, 147456
    s_add_u32 s89, s96, 81920
    buffer_load_dwordx4 v4, s[28:31], s89 offen sc1 lds
    v_mfma_f32_16x16x32_bf16 v[212:215], v[188:191], a[52:55], v[212:215]
    ds_read_b64_tr_b16 v[204:205], v29 offset:49160
    ds_read_b64_tr_b16 v[206:207], v29 offset:49928
    v_add_f32 v68, v68, v72
    v_mfma_f32_16x16x32_bf16 v[216:219], v[184:187], a[116:119], v[216:219]
    v_and_b32 v73, s39, v94
    v_add_f32 v69, v69, v73
    v_mfma_f32_16x16x32_bf16 v[220:223], v[188:191], a[116:119], v[220:223]
    v_lshlrev_b32 v74, 16, v95
    v_mfma_f32_16x16x32_bf16 v[224:227], v[184:187], a[180:183], v[224:227]
    v_add_f32 v70, v70, v74
    v_and_b32 v75, s39, v95
    v_mfma_f32_16x16x32_bf16 v[228:231], v[188:191], a[180:183], v[228:231]
    v_add_f32 v71, v71, v75
    v_mfma_f32_16x16x32_bf16 v[232:235], v[184:187], a[244:247], v[232:235]
    v_mul_f32 v64, v64, v112
    v_mul_f32 v65, v65, v113
    v_mfma_f32_16x16x32_bf16 v[236:239], v[188:191], a[244:247], v[236:239]
    v_mul_f32 v66, v66, v114
    s_waitcnt lgkmcnt(0)
    v_mfma_f32_16x16x32_bf16 v[232:235], v[192:195], a[248:251], v[232:235]
    s_add_u32 m0, s38, 151552
    s_add_u32 s89, s96, 86016
    v_mfma_f32_16x16x32_bf16 v[236:239], v[196:199], a[248:251], v[236:239]
    buffer_load_dwordx4 v4, s[28:31], s89 offen sc1 lds
    v_mul_f32 v67, v67, v115
    v_mfma_f32_16x16x32_bf16 v[232:235], v[200:203], a[252:255], v[232:235]
    v_mul_f32 v68, v68, v116
    v_mfma_f32_16x16x32_bf16 v[236:239], v[204:207], a[252:255], v[236:239]
    v_mfma_f32_16x16x32_bf16 v[224:227], v[192:195], a[184:187], v[224:227]
    s_add_u32 m0, s38, 155648
    s_add_u32 s89, s96, 90112
    v_mfma_f32_16x16x32_bf16 v[228:231], v[196:199], a[184:187], v[228:231]
    buffer_load_dwordx4 v4, s[28:31], s89 offen sc1 lds
    v_mul_f32 v69, v69, v117
    v_mul_f32 v70, v70, v118
    v_mul_f32 v71, v71, v119
    v_cvt_pk_bf16_f32 v244, v64, v65
    v_cvt_pk_bf16_f32 v245, v66, v67
    v_cvt_pk_bf16_f32 v246, v68, v69
    v_cvt_pk_bf16_f32 v247, v70, v71
    v_or_b32 v244, 1, v244
    buffer_store_dwordx4 v[244:247], v161, s[28:31], s83 offen offset:2048 sc1
    v_mfma_f32_16x16x32_bf16 v[224:227], v[200:203], a[188:191], v[224:227]
    v_mfma_f32_16x16x32_bf16 v[228:231], v[204:207], a[188:191], v[228:231]
    v_cvt_pk_bf16_f32 v232, v232, v233
    v_cvt_pk_bf16_f32 v233, v234, v235
    v_cvt_pk_bf16_f32 v234, v236, v237
    v_cvt_pk_bf16_f32 v235, v238, v239
    ds_write_b128 v164, v[232:235] offset:2048
    v_mfma_f32_16x16x32_bf16 v[216:219], v[192:195], a[120:123], v[216:219]
    s_add_u32 s89, s45, 0
    v_mfma_f32_16x16x32_bf16 v[220:223], v[196:199], a[120:123], v[220:223]
    buffer_load_dwordx4 v[32:35], v4, s[28:31], s89 offen offset:0 sc1
    v_mfma_f32_16x16x32_bf16 v[216:219], v[200:203], a[124:127], v[216:219]
    v_mfma_f32_16x16x32_bf16 v[220:223], v[204:207], a[124:127], v[220:223]
    v_cvt_pk_bf16_f32 v224, v224, v225
    v_cvt_pk_bf16_f32 v225, v226, v227
    v_cvt_pk_bf16_f32 v226, v228, v229
    v_cvt_pk_bf16_f32 v227, v230, v231
    ds_write_b128 v164, v[224:227] offset:1024
    v_mfma_f32_16x16x32_bf16 v[208:211], v[192:195], a[56:59], v[208:211]
    v_mfma_f32_16x16x32_bf16 v[212:215], v[196:199], a[56:59], v[212:215]
    v_mfma_f32_16x16x32_bf16 v[208:211], v[200:203], a[60:63], v[208:211]
    v_mfma_f32_16x16x32_bf16 v[212:215], v[204:207], a[60:63], v[212:215]
    v_cvt_pk_bf16_f32 v216, v216, v217
    v_cvt_pk_bf16_f32 v217, v218, v219
    v_cvt_pk_bf16_f32 v218, v220, v221
    v_cvt_pk_bf16_f32 v219, v222, v223
    ds_write_b128 v164, v[216:219] offset:0
    s_add_u32 s89, s45, 0
    buffer_load_dwordx4 v[36:39], v4, s[28:31], s89 offen offset:1024 sc1
    v_pk_add_f32 v[208:209], v[208:209], v[18:19] op_sel_hi:[1,0]
    v_pk_add_f32 v[210:211], v[210:211], v[18:19] op_sel_hi:[1,0]
    v_pk_add_f32 v[212:213], v[212:213], v[18:19] op_sel_hi:[1,0]
    v_pk_add_f32 v[214:215], v[214:215], v[18:19] op_sel_hi:[1,0]
    s_waitcnt lgkmcnt(0)
    s_barrier
    ds_read_b128 v[220:223], v165 offset:0
    ds_read_b128 v[228:231], v166 offset:1024
    ds_read_b128 v[236:239], v167 offset:2048
    s_add_u32 s89, s45, 4096
    buffer_load_dwordx4 v[40:43], v4, s[28:31], s89 offen offset:0 sc1
    s_waitcnt lgkmcnt(2)
    v_dot2c_f32_bf16 v208, v220, v162
    v_dot2c_f32_bf16 v209, v220, v163
    v_dot2c_f32_bf16 v210, v221, v162
    v_dot2c_f32_bf16 v211, v221, v163
    v_dot2c_f32_bf16 v212, v222, v162
    v_dot2c_f32_bf16 v213, v222, v163
    v_dot2c_f32_bf16 v214, v223, v162
    v_dot2c_f32_bf16 v215, v223, v163
    s_add_u32 s89, s45, 4096
    buffer_load_dwordx4 v[44:47], v4, s[28:31], s89 offen offset:1024 sc1
    s_waitcnt lgkmcnt(1)
    v_dot2c_f32_bf16 v208, v228, v162
    v_dot2c_f32_bf16 v209, v228, v163
    v_dot2c_f32_bf16 v210, v229, v162
    v_dot2c_f32_bf16 v211, v229, v163
    v_dot2c_f32_bf16 v212, v230, v162
    v_dot2c_f32_bf16 v213, v230, v163
    v_dot2c_f32_bf16 v214, v231, v162
    v_dot2c_f32_bf16 v215, v231, v163
    s_add_u32 s89, s45, 8192
    buffer_load_dwordx4 v[48:51], v4, s[28:31], s89 offen offset:0 sc1
    s_waitcnt lgkmcnt(0)
    v_dot2c_f32_bf16 v208, v236, v162
    v_dot2c_f32_bf16 v209, v236, v163
    v_dot2c_f32_bf16 v210, v237, v162
    v_dot2c_f32_bf16 v211, v237, v163
    v_dot2c_f32_bf16 v212, v238, v162
    v_dot2c_f32_bf16 v213, v238, v163
    v_dot2c_f32_bf16 v214, v239, v162
    v_dot2c_f32_bf16 v215, v239, v163
    s_add_u32 s89, s45, 8192
    buffer_load_dwordx4 v[52:55], v4, s[28:31], s89 offen offset:1024 sc1
    v_pk_mul_f32 v[208:209], v[208:209], v[128:129]
    v_pk_mul_f32 v[210:211], v[210:211], v[130:131]
    v_pk_mul_f32 v[212:213], v[212:213], v[132:133]
    v_pk_mul_f32 v[214:215], v[214:215], v[134:135]
    v_cvt_pk_bf16_f32 v248, v208, v209
    v_cvt_pk_bf16_f32 v249, v210, v211
    v_cvt_pk_bf16_f32 v250, v212, v213
    v_cvt_pk_bf16_f32 v251, v214, v215
    s_add_u32 s89, s45, 12288
    buffer_load_dwordx4 v[56:59], v4, s[28:31], s89 offen offset:0 sc1
    buffer_store_dwordx4 v[248:251], v26, s[28:31], s84 offen sc1
    s_add_u32 s89, s45, 12288
    buffer_load_dwordx4 v[60:63], v4, s[28:31], s89 offen offset:1024 sc1
    s_add_u32 s89, s45, 2048
    buffer_load_dwordx4 v[64:67], v4, s[28:31], s89 offen offset:0 sc1
    s_add_u32 s89, s45, 2048
    buffer_load_dwordx4 v[68:71], v4, s[28:31], s89 offen offset:1024 sc1
    s_add_u32 s89, s45, 6144
    buffer_load_dwordx4 v[72:75], v4, s[28:31], s89 offen offset:0 sc1
    s_add_u32 s89, s45, 6144
    buffer_load_dwordx4 v[76:79], v4, s[28:31], s89 offen offset:1024 sc1
    s_add_u32 s89, s45, 10240
    buffer_load_dwordx4 v[80:83], v4, s[28:31], s89 offen offset:0 sc1
    s_add_u32 s89, s45, 10240
    buffer_load_dwordx4 v[84:87], v4, s[28:31], s89 offen offset:1024 sc1
    s_add_u32 s89, s45, 14336
    buffer_load_dwordx4 v[88:91], v4, s[28:31], s89 offen offset:0 sc1
    s_add_u32 s89, s45, 14336
    buffer_load_dwordx4 v[92:95], v4, s[28:31], s89 offen offset:1024 sc1
    s_waitcnt vmcnt(18)
    s_barrier
    ds_read_b128 v[176:179], v25 offset:0
    ds_read_b128 v[180:183], v25 offset:1024
    ds_read_b128 v[184:187], v25 offset:2048
    ds_read_b128 v[188:191], v25 offset:3072
    ds_read_b128 v[192:195], v25 offset:12288
    ds_read_b128 v[196:199], v25 offset:13312
    s_waitcnt vmcnt(8)
L_ag_21:
    v_and_b32 v6, 1, v32
    v_bitop3_b32 v6, v6, v36, v40 bitop3:0x80
    v_bitop3_b32 v6, v6, v44, v48 bitop3:0x80
    v_bitop3_b32 v6, v6, v52, v56 bitop3:0x80
    v_and_b32 v6, v6, v60
    v_cmp_eq_u32 vcc, 0, v6
    s_cbranch_vccnz L_rt_22
L_rc_23:
    s_waitcnt lgkmcnt(4)
    v_mfma_f32_32x32x16_bf16 v[144:159], v[176:179], v[32:35], v[144:159]
    ds_read_b128 v[200:203], v25 offset:14336
    ds_read_b128 v[204:207], v25 offset:15360
    v_mfma_f32_32x32x16_bf16 v[208:223], v[180:183], v[32:35], 0
    s_add_u32 s89, s85, 4096
    buffer_load_dwordx4 v[96:99], v4, s[28:31], s89 offen offset:0 sc1
    s_waitcnt lgkmcnt(4)
    v_mfma_f32_32x32x16_bf16 v[144:159], v[184:187], v[36:39], v[144:159]
    ds_read_b128 v[176:179], v25 offset:24576
    ds_read_b128 v[180:183], v25 offset:25600
    v_mfma_f32_32x32x16_bf16 v[208:223], v[188:191], v[36:39], v[208:223]
    s_add_u32 s89, s85, 4096
    buffer_load_dwordx4 v[100:103], v12, s[28:31], s89 offen offset:1024 sc1
    s_waitcnt lgkmcnt(4)
    v_mfma_f32_32x32x16_bf16 v[144:159], v[192:195], v[40:43], v[144:159]
    ds_read_b128 v[184:187], v25 offset:26624
    ds_read_b128 v[188:191], v25 offset:27648
    v_mfma_f32_32x32x16_bf16 v[208:223], v[196:199], v[40:43], v[208:223]
    s_add_u32 s89, s85, 10240
    buffer_load_dwordx4 v[104:107], v4, s[28:31], s89 offen offset:0 sc1
    s_waitcnt lgkmcnt(4)
    v_mfma_f32_32x32x16_bf16 v[144:159], v[200:203], v[44:47], v[144:159]
    ds_read_b128 v[192:195], v25 offset:36864
    ds_read_b128 v[196:199], v25 offset:37888
    v_mfma_f32_32x32x16_bf16 v[208:223], v[204:207], v[44:47], v[208:223]
    s_add_u32 s89, s85, 10240
    buffer_load_dwordx4 v[108:111], v12, s[28:31], s89 offen offset:1024 sc1
    s_waitcnt lgkmcnt(4)
    v_mfma_f32_32x32x16_bf16 v[144:159], v[176:179], v[48:51], v[144:159]
    ds_read_b128 v[200:203], v25 offset:38912
    ds_read_b128 v[204:207], v25 offset:39936
    v_mfma_f32_32x32x16_bf16 v[208:223], v[180:183], v[48:51], v[208:223]
    s_add_u32 s89, s85, 16384
    buffer_load_dwordx4 v[112:115], v4, s[28:31], s89 offen offset:0 sc1
    s_waitcnt lgkmcnt(4)
    v_mfma_f32_32x32x16_bf16 v[144:159], v[184:187], v[52:55], v[144:159]
    ds_read_b128 v[176:179], v25 offset:4096
    ds_read_b128 v[180:183], v25 offset:5120
    v_mfma_f32_32x32x16_bf16 v[208:223], v[188:191], v[52:55], v[208:223]
    s_add_u32 s89, s85, 16384
    buffer_load_dwordx4 v[116:119], v12, s[28:31], s89 offen offset:1024 sc1
    s_waitcnt lgkmcnt(4)
    v_mfma_f32_32x32x16_bf16 v[144:159], v[192:195], v[56:59], v[144:159]
    ds_read_b128 v[184:187], v25 offset:6144
    ds_read_b128 v[188:191], v25 offset:7168
    v_mfma_f32_32x32x16_bf16 v[208:223], v[196:199], v[56:59], v[208:223]
    s_add_u32 s89, s85, 22528
    buffer_load_dwordx4 v[120:123], v4, s[28:31], s89 offen offset:0 sc1
    s_waitcnt lgkmcnt(4)
    v_mfma_f32_32x32x16_bf16 v[144:159], v[200:203], v[60:63], v[144:159]
    ds_read_b128 v[192:195], v25 offset:16384
    ds_read_b128 v[196:199], v25 offset:17408
    v_mfma_f32_32x32x16_bf16 v[208:223], v[204:207], v[60:63], v[208:223]
    s_waitcnt vmcnt(7)
L_ag_24:
    v_and_b32 v6, 1, v64
    v_bitop3_b32 v6, v6, v68, v72 bitop3:0x80
    v_bitop3_b32 v6, v6, v76, v80 bitop3:0x80
    v_bitop3_b32 v6, v6, v84, v88 bitop3:0x80
    v_and_b32 v6, v6, v92
    v_cmp_eq_u32 vcc, 0, v6
    s_cbranch_vccnz L_rt_25
L_rc_26:
    s_waitcnt lgkmcnt(4)
    v_mfma_f32_32x32x16_bf16 v[144:159], v[176:179], v[64:67], v[144:159]
    ds_read_b128 v[200:203], v25 offset:18432
    ds_read_b128 v[204:207], v25 offset:19456
    v_mfma_f32_32x32x16_bf16 v[208:223], v[180:183], v[64:67], v[208:223]
    s_waitcnt lgkmcnt(4)
    v_mfma_f32_32x32x16_bf16 v[144:159], v[184:187], v[68:71], v[144:159]
    ds_read_b128 v[176:179], v25 offset:28672
    ds_read_b128 v[180:183], v25 offset:29696
    v_mfma_f32_32x32x16_bf16 v[208:223], v[188:191], v[68:71], v[208:223]
    s_waitcnt lgkmcnt(4)
    v_mfma_f32_32x32x16_bf16 v[144:159], v[192:195], v[72:75], v[144:159]
    ds_read_b128 v[184:187], v25 offset:30720
    ds_read_b128 v[188:191], v25 offset:31744
    v_mfma_f32_32x32x16_bf16 v[208:223], v[196:199], v[72:75], v[208:223]
    s_waitcnt lgkmcnt(4)
    v_mfma_f32_32x32x16_bf16 v[144:159], v[200:203], v[76:79], v[144:159]
    ds_read_b128 v[192:195], v25 offset:40960
    ds_read_b128 v[196:199], v25 offset:41984
    v_mfma_f32_32x32x16_bf16 v[208:223], v[204:207], v[76:79], v[208:223]
    s_waitcnt lgkmcnt(4)
    v_mfma_f32_32x32x16_bf16 v[144:159], v[176:179], v[80:83], v[144:159]
    ds_read_b128 v[200:203], v25 offset:43008
    ds_read_b128 v[204:207], v25 offset:44032
    v_mfma_f32_32x32x16_bf16 v[208:223], v[180:183], v[80:83], v[208:223]
    s_waitcnt lgkmcnt(4)
    v_mfma_f32_32x32x16_bf16 v[144:159], v[184:187], v[84:87], v[144:159]
    ds_read_b128 v[32:35], v25 offset:8192
    ds_read_b128 v[224:227], v25 offset:9216
    v_mfma_f32_32x32x16_bf16 v[208:223], v[188:191], v[84:87], v[208:223]
    s_waitcnt lgkmcnt(4)
    v_mfma_f32_32x32x16_bf16 v[144:159], v[192:195], v[88:91], v[144:159]
    ds_read_b128 v[36:39], v25 offset:10240
    ds_read_b128 v[228:231], v25 offset:11264
    v_mfma_f32_32x32x16_bf16 v[208:223], v[196:199], v[88:91], v[208:223]
    s_waitcnt lgkmcnt(4)
    v_mfma_f32_32x32x16_bf16 v[144:159], v[200:203], v[92:95], v[144:159]
    ds_read_b128 v[40:43], v25 offset:20480
    ds_read_b128 v[232:235], v25 offset:21504
    v_mfma_f32_32x32x16_bf16 v[208:223], v[204:207], v[92:95], v[208:223]
    ds_read_b128 v[44:47], v25 offset:22528
    ds_read_b128 v[236:239], v25 offset:23552
    ds_read_b128 v[48:51], v25 offset:32768
    ds_read_b128 v[240:243], v25 offset:33792
    ds_read_b128 v[52:55], v25 offset:34816
    ds_read_b128 v[244:247], v25 offset:35840
    ds_read_b128 v[56:59], v25 offset:45056
    ds_read_b128 v[248:251], v25 offset:46080
    s_waitcnt vmcnt(0)
L_ag_27:
    v_max3_u32 v6, v96, v100, v104
    v_max3_u32 v6, v6, v108, v112
    v_max3_u32 v6, v6, v116, v120
    v_cmp_eq_u32 vcc, -1, v6
    s_cbranch_vccnz L_rt_28
L_rc_29:
    s_waitcnt lgkmcnt(12)
    v_mfma_f32_32x32x16_bf16 v[208:223], v[224:227], v[96:99], v[208:223]
    s_waitcnt lgkmcnt(10)
    v_mfma_f32_32x32x16_bf16 v[208:223], v[228:231], v[100:103], v[208:223]
    s_waitcnt lgkmcnt(8)
    v_mfma_f32_32x32x16_bf16 v[208:223], v[232:235], v[104:107], v[208:223]
    s_waitcnt lgkmcnt(6)
    v_mfma_f32_32x32x16_bf16 v[208:223], v[236:239], v[108:111], v[208:223]
    s_waitcnt lgkmcnt(4)
    v_mfma_f32_32x32x16_bf16 v[208:223], v[240:243], v[112:115], v[208:223]
    s_waitcnt lgkmcnt(2)
    v_mfma_f32_32x32x16_bf16 v[208:223], v[244:247], v[116:119], v[208:223]
    s_waitcnt lgkmcnt(0)
    v_mfma_f32_32x32x16_bf16 v[208:223], v[248:251], v[120:123], v[208:223]
    v_mfma_f32_32x32x16_bf16 v[144:159], v[32:35], v[96:99], v[144:159]
    v_mfma_f32_32x32x16_bf16 v[144:159], v[36:39], v[100:103], v[144:159]
    v_mfma_f32_32x32x16_bf16 v[144:159], v[40:43], v[104:107], v[144:159]
    s_nop 8
    ds_write_b128 v164, v[208:211] offset:32768
    v_mfma_f32_32x32x16_bf16 v[144:159], v[44:47], v[108:111], v[144:159]
    ds_write_b128 v164, v[212:215] offset:33792
    v_mfma_f32_32x32x16_bf16 v[144:159], v[48:51], v[112:115], v[144:159]
    ds_write_b128 v164, v[216:219] offset:34816
    v_mfma_f32_32x32x16_bf16 v[144:159], v[52:55], v[116:119], v[144:159]
    ds_write_b128 v164, v[220:223] offset:35840
    v_mfma_f32_32x32x16_bf16 v[144:159], v[56:59], v[120:123], v[144:159]
    s_waitcnt lgkmcnt(0)
    s_barrier
    ds_read_b128 v[208:211], v165 offset:32768
    ds_read_b128 v[212:215], v165 offset:33792
    ds_read_b128 v[216:219], v165 offset:34816
    ds_read_b128 v[220:223], v165 offset:35840
    s_waitcnt lgkmcnt(3)
    s_nop 4
    v_pk_add_f32 v[144:145], v[144:145], v[208:209]
    v_pk_add_f32 v[146:147], v[146:147], v[210:211]
    s_waitcnt lgkmcnt(2)
    v_pk_add_f32 v[148:149], v[148:149], v[212:213]
    v_pk_add_f32 v[150:151], v[150:151], v[214:215]
    v_cvt_pk_bf16_f32 v176, v144, v145
    v_cvt_pk_bf16_f32 v177, v146, v147
    v_cvt_pk_bf16_f32 v178, v148, v149
    v_cvt_pk_bf16_f32 v179, v150, v151
    ds_write_b128 v27, v[176:179] offset:49152
    s_waitcnt lgkmcnt(2)
    v_pk_add_f32 v[152:153], v[152:153], v[216:217]
    v_pk_add_f32 v[154:155], v[154:155], v[218:219]
    s_waitcnt lgkmcnt(1)
    v_pk_add_f32 v[156:157], v[156:157], v[220:221]
    v_pk_add_f32 v[158:159], v[158:159], v[222:223]
    v_cvt_pk_bf16_f32 v180, v152, v153
    v_cvt_pk_bf16_f32 v181, v154, v155
    v_cvt_pk_bf16_f32 v182, v156, v157
    v_cvt_pk_bf16_f32 v183, v158, v159
    ds_write_b128 v27, v[180:183] offset:49184
    ds_read_b128 v[184:187], v14 offset:49152
    ds_read_b128 v[188:191], v14 offset:50432
    s_waitcnt lgkmcnt(1)
    buffer_store_dwordx4 v[184:187], v15, s[24:27], s76 offen sc1
    s_waitcnt lgkmcnt(0)
    buffer_store_dwordx4 v[188:191], v15, s[24:27], s77 offen sc1
L_end:
    s_endpgm
L_rt_2:
    s_cmp_eq_u32 s69, 0
    s_cbranch_scc1 L_rc_3
    s_sub_u32 s69, s69, 1
    s_mov_b32 s75, m0
    s_waitcnt lgkmcnt(0)
    buffer_load_dwordx4 v[168:171], v9, s[28:31], 0 offen offset:0 sc1
    s_waitcnt vmcnt(0)
    s_mov_b32 m0, s75
    s_branch L_ag_1
L_rt_5:
    s_cmp_eq_u32 s69, 0
    s_cbranch_scc1 L_rc_6
    s_sub_u32 s69, s69, 1
    s_mov_b32 s75, m0
    s_waitcnt lgkmcnt(0)
    s_add_u32 m0, s86, 12288
    s_add_u32 s72, s88, 0
    buffer_load_dwordx4 v4, s[28:31], s72 offen offset:0 sc1 lds
    buffer_load_dwordx4 v4, s[28:31], s72 offen offset:1024 sc1 lds
    buffer_load_dwordx4 v4, s[28:31], s72 offen offset:2048 sc1 lds
    buffer_load_dwordx4 v4, s[28:31], s72 offen offset:3072 sc1 lds
    s_add_u32 m0, s86, 8192
    s_add_u32 s72, s88, 8192
    buffer_load_dwordx4 v4, s[28:31], s72 offen offset:0 sc1 lds
    buffer_load_dwordx4 v4, s[28:31], s72 offen offset:1024 sc1 lds
    buffer_load_dwordx4 v4, s[28:31], s72 offen offset:2048 sc1 lds
    buffer_load_dwordx4 v4, s[28:31], s72 offen offset:3072 sc1 lds
    s_waitcnt vmcnt(0)
    ds_read2st64_b32 v[224:225], v13 offset0:48 offset1:52
    ds_read2st64_b32 v[226:227], v13 offset0:56 offset1:60
    ds_read2st64_b32 v[228:229], v13 offset0:32 offset1:36
    ds_read2st64_b32 v[230:231], v13 offset0:40 offset1:44
    s_waitcnt lgkmcnt(0)
    s_waitcnt vmcnt(0)
    s_mov_b32 m0, s75
    s_branch L_ag_4
L_rt_8:
    s_cmp_eq_u32 s69, 0
    s_cbranch_scc1 L_rc_9
    s_sub_u32 s69, s69, 1
    s_mov_b32 s75, m0
    s_waitcnt lgkmcnt(0)
    s_add_u32 m0, s86, 4096
    s_add_u32 s72, s88, 16384
    buffer_load_dwordx4 v4, s[28:31], s72 offen offset:0 sc1 lds
    buffer_load_dwordx4 v4, s[28:31], s72 offen offset:1024 sc1 lds
    buffer_load_dwordx4 v4, s[28:31], s72 offen offset:2048 sc1 lds
    buffer_load_dwordx4 v4, s[28:31], s72 offen offset:3072 sc1 lds
    s_add_u32 m0, s86, 0
    s_add_u32 s72, s88, 24576
    buffer_load_dwordx4 v4, s[28:31], s72 offen offset:0 sc1 lds
    buffer_load_dwordx4 v4, s[28:31], s72 offen offset:1024 sc1 lds
    buffer_load_dwordx4 v4, s[28:31], s72 offen offset:2048 sc1 lds
    buffer_load_dwordx4 v4, s[28:31], s72 offen offset:3072 sc1 lds
    s_waitcnt vmcnt(0)
    ds_read2st64_b32 v[224:225], v13 offset0:16 offset1:20
    ds_read2st64_b32 v[226:227], v13 offset0:24 offset1:28
    ds_read2st64_b32 v[228:229], v13 offset0:0 offset1:4
    ds_read2st64_b32 v[230:231], v13 offset0:8 offset1:12
    s_waitcnt lgkmcnt(0)
    s_waitcnt vmcnt(0)
    s_mov_b32 m0, s75
    s_branch L_ag_7
L_rt_11:
    s_cmp_eq_u32 s69, 0
    s_cbranch_scc1 L_rc_12
    s_sub_u32 s69, s69, 1
    s_mov_b32 s75, m0
    s_waitcnt lgkmcnt(0)
    buffer_load_dword v144, v12, s[28:31], s81 offen offset:0 sc1
    buffer_load_dword v145, v12, s[28:31], s81 offen offset:256 sc1
    buffer_load_dword v146, v12, s[28:31], s81 offen offset:512 sc1
    buffer_load_dword v147, v12, s[28:31], s81 offen offset:768 sc1
    buffer_load_dword v148, v12, s[28:31], s81 offen offset:1024 sc1
    buffer_load_dword v149, v12, s[28:31], s81 offen offset:1280 sc1
    buffer_load_dword v150, v12, s[28:31], s81 offen offset:1536 sc1
    buffer_load_dword v151, v12, s[28:31], s81 offen offset:1792 sc1
    buffer_load_dword v152, v12, s[28:31], s81 offen offset:2048 sc1
    buffer_load_dword v153, v12, s[28:31], s81 offen offset:2304 sc1
    buffer_load_dword v154, v12, s[28:31], s81 offen offset:2560 sc1
    buffer_load_dword v155, v12, s[28:31], s81 offen offset:2816 sc1
    buffer_load_dword v156, v12, s[28:31], s81 offen offset:3072 sc1
    buffer_load_dword v157, v12, s[28:31], s81 offen offset:3328 sc1
    buffer_load_dword v158, v12, s[28:31], s81 offen offset:3584 sc1
    buffer_load_dword v159, v12, s[28:31], s81 offen offset:3840 sc1
    s_waitcnt vmcnt(0)
    s_mov_b32 m0, s75
    s_branch L_ag_10
L_rt_19:
    s_cmp_eq_u32 s69, 0
    s_cbranch_scc1 L_rc_20
    s_sub_u32 s69, s69, 1
    s_mov_b32 s75, m0
    s_waitcnt lgkmcnt(0)
    s_mul_i32 s6, s58, 512
    s_add_u32 s6, s6, 14680064
    v_lshrrev_b32 v244, 3, v2
    v_mul_u32_u24 v244, 0, v244
    v_lshl_add_u32 v24, v2, 4, v244
    buffer_load_dwordx4 v[244:247], v24, s[28:31], s6 offen sc1
    s_waitcnt vmcnt(0)
    s_mov_b32 m0, s75
    s_branch L_ag_18
L_rt_22:
    s_cmp_eq_u32 s69, 0
    s_cbranch_scc1 L_rc_23
    s_sub_u32 s69, s69, 1
    s_mov_b32 s75, m0
    s_waitcnt lgkmcnt(0)
    s_add_u32 s74, s45, 0
    buffer_load_dwordx4 v[32:35], v4, s[28:31], s74 offen offset:0 sc1
    s_add_u32 s74, s45, 0
    buffer_load_dwordx4 v[36:39], v4, s[28:31], s74 offen offset:1024 sc1
    s_add_u32 s74, s45, 4096
    buffer_load_dwordx4 v[40:43], v4, s[28:31], s74 offen offset:0 sc1
    s_add_u32 s74, s45, 4096
    buffer_load_dwordx4 v[44:47], v4, s[28:31], s74 offen offset:1024 sc1
    s_add_u32 s74, s45, 8192
    buffer_load_dwordx4 v[48:51], v4, s[28:31], s74 offen offset:0 sc1
    s_add_u32 s74, s45, 8192
    buffer_load_dwordx4 v[52:55], v4, s[28:31], s74 offen offset:1024 sc1
    s_add_u32 s74, s45, 12288
    buffer_load_dwordx4 v[56:59], v4, s[28:31], s74 offen offset:0 sc1
    s_add_u32 s74, s45, 12288
    buffer_load_dwordx4 v[60:63], v4, s[28:31], s74 offen offset:1024 sc1
    s_waitcnt vmcnt(0)
    s_mov_b32 m0, s75
    s_branch L_ag_21
L_rt_25:
    s_cmp_eq_u32 s69, 0
    s_cbranch_scc1 L_rc_26
    s_sub_u32 s69, s69, 1
    s_mov_b32 s75, m0
    s_waitcnt lgkmcnt(0)
    s_add_u32 s74, s45, 2048
    buffer_load_dwordx4 v[64:67], v4, s[28:31], s74 offen offset:0 sc1
    s_add_u32 s74, s45, 2048
    buffer_load_dwordx4 v[68:71], v4, s[28:31], s74 offen offset:1024 sc1
    s_add_u32 s74, s45, 6144
    buffer_load_dwordx4 v[72:75], v4, s[28:31], s74 offen offset:0 sc1
    s_add_u32 s74, s45, 6144
    buffer_load_dwordx4 v[76:79], v4, s[28:31], s74 offen offset:1024 sc1
    s_add_u32 s74, s45, 10240
    buffer_load_dwordx4 v[80:83], v4, s[28:31], s74 offen offset:0 sc1
    s_add_u32 s74, s45, 10240
    buffer_load_dwordx4 v[84:87], v4, s[28:31], s74 offen offset:1024 sc1
    s_add_u32 s74, s45, 14336
    buffer_load_dwordx4 v[88:91], v4, s[28:31], s74 offen offset:0 sc1
    s_add_u32 s74, s45, 14336
    buffer_load_dwordx4 v[92:95], v4, s[28:31], s74 offen offset:1024 sc1
    s_waitcnt vmcnt(0)
    s_mov_b32 m0, s75
    s_branch L_ag_24
L_rt_28:
    s_cmp_eq_u32 s69, 0
    s_cbranch_scc1 L_rc_29
    s_sub_u32 s69, s69, 1
    s_mov_b32 s75, m0
    s_waitcnt lgkmcnt(0)
    s_add_u32 s74, s85, 4096
    buffer_load_dwordx4 v[96:99], v4, s[28:31], s74 offen offset:0 sc1
    s_add_u32 s74, s85, 4096
    buffer_load_dwordx4 v[100:103], v12, s[28:31], s74 offen offset:1024 sc1
    s_add_u32 s74, s85, 10240
    buffer_load_dwordx4 v[104:107], v4, s[28:31], s74 offen offset:0 sc1
    s_add_u32 s74, s85, 10240
    buffer_load_dwordx4 v[108:111], v12, s[28:31], s74 offen offset:1024 sc1
    s_add_u32 s74, s85, 16384
    buffer_load_dwordx4 v[112:115], v4, s[28:31], s74 offen offset:0 sc1
    s_add_u32 s74, s85, 16384
    buffer_load_dwordx4 v[116:119], v12, s[28:31], s74 offen offset:1024 sc1
    s_add_u32 s74, s85, 22528
    buffer_load_dwordx4 v[120:123], v4, s[28:31], s74 offen offset:0 sc1
    s_waitcnt vmcnt(0)
    s_mov_b32 m0, s75
    s_branch L_ag_27
L_codeend:
.section .rodata,"a"
.p2align 6
.amdhsa_kernel sequential_preLN__spectral_fnet__mixer_gmlp__prompt_kernel
  .amdhsa_next_free_vgpr 512
  .amdhsa_next_free_sgpr 102
  .amdhsa_accum_offset 256
  .amdhsa_group_segment_fixed_size 0
  .amdhsa_kernarg_size 104
  .amdhsa_user_sgpr_count 2
  .amdhsa_user_sgpr_kernarg_segment_ptr 1
  .amdhsa_system_sgpr_workgroup_id_x 1
.end_amdhsa_kernel
```
